```python
import torch

def _softmax(x, axis=-1):
    return torch.softmax(x, dim=axis)
def _gelu(x):
    return torch.nn.functional.gelu(x, approximate="tanh")
def _silu(x):
    return torch.nn.functional.silu(x)
def _sigmoid(x):
    return torch.sigmoid(x)
def _layernorm(x, axis=-1, eps=1e-5):
    m = x.mean(dim=axis, keepdim=True)
    v = x.var(dim=axis, keepdim=True, unbiased=False)
    return (x - m) / torch.sqrt(v + eps)
def _scatter_add(tgt, idx, src, axis=0):
    return tgt.clone().index_add_(axis, idx, src)
def _segment_sum(src, seg, n):
    out = torch.zeros((n,) + src.shape[1:], dtype=src.dtype)
    return out.index_add_(0, seg, src)
def _pad(x, pw):
    flat = tuple(v for pair in reversed(pw) for v in pair)
    return torch.nn.functional.pad(x, flat)

kernel_name = 'parallel_sum__sliding_block_cached__glu_gated_glu__decode'

def setup_inputs():

    _w = (lambda a: (lambda t: t.to(torch.bfloat16) if t.is_floating_point() else t)(torch.as_tensor(a)))
    def _A_setup():
        B, Sq, D = 2, 1, 512
        Hq, Hkv, Sk, Dh = 32, 8, 32768, 128
        assert Hq % Hkv == 0, (Hq, Hkv)
        return {
            "x": _w((lambda *s: torch.randn(*s, dtype=torch.bfloat16) * 0.05)(B, Sq, D)),
            "k_cache": _w((lambda *s: torch.randn(*s, dtype=torch.bfloat16) * 3.2)(B, Hkv, Sk, Dh)),
            "v_cache": _w((lambda *s: torch.randn(*s, dtype=torch.bfloat16) * 1.6)(B, Hkv, Sk, Dh)),
            "wq": _w((lambda *s: torch.randn(*s, dtype=torch.bfloat16) * 3.2)(D, Hq * Dh) * (D ** -0.5)),
            "wo": _w((lambda *s: torch.randn(*s, dtype=torch.bfloat16) * 1.6)(Hq * Dh, D) * ((Hq * Dh) ** -0.5)),
        }
    _A_in = _A_setup()

    def _B_setup():
        B, S, D, F = 2, 1, 512, 1792
        return {
            "x": _w((lambda *s: torch.randn(*s, dtype=torch.bfloat16) * 0.05)(B, S, D)),
            "w_gate": _w((lambda *s: torch.randn(*s, dtype=torch.bfloat16) * 1.6)(D, F)),
            "w_up": _w((lambda *s: torch.randn(*s, dtype=torch.bfloat16) * 0.05)(D, F)),
            "w_down": _w((lambda *s: torch.randn(*s, dtype=torch.bfloat16) * 0.05)(F, D)),
        }
    _B_in = _B_setup()

    return {
        "A_x": _A_in["x"],
        "A_k_cache": _A_in["k_cache"],
        "A_v_cache": _A_in["v_cache"],
        "A_wq": _A_in["wq"],
        "A_wo": _A_in["wo"],
        "B_x": _B_in["x"],
        "B_w_gate": _B_in["w_gate"],
        "B_w_up": _B_in["w_up"],
        "B_w_down": _B_in["w_down"],
    }

def reference(A_x, A_k_cache, A_v_cache, A_wq, A_wo, B_x, B_w_gate, B_w_up, B_w_down):
    def _A_ref(x, k_cache, v_cache, wq, wo):
        B, Sq, D = x.shape
        Hq, Dh = 32, 128
        Hkv, Sk = k_cache.shape[1], k_cache.shape[2]
        W = min(4096, max(256, Sk // 4))
        rep = Hq // Hkv
        q = (lambda x, *d: x.permute(*d))((x @ wq).reshape(B, Sq, Hq, Dh), 0, 2, 1, 3)
        k = (lambda x, n, axis: torch.repeat_interleave(x, n, dim=axis))(k_cache[:, :, Sk - W:, :], rep, axis=1)
        v = (lambda x, n, axis: torch.repeat_interleave(x, n, dim=axis))(v_cache[:, :, Sk - W:, :], rep, axis=1)
        scores = torch.einsum("bhqd,bhkd->bhqk", q, k) * (Dh ** -0.5)
        p = _softmax(scores, axis=-1)
        o = torch.einsum("bhqk,bhkd->bhqd", p, v)
        return (lambda x, *d: x.permute(*d))(o, 0, 2, 1, 3).reshape(B, Sq, Hq * Dh) @ wo

    def _B_ref(x, w_gate, w_up, w_down):
        g = torch.einsum("bsd,df->bsf", x, w_gate)
        u = torch.einsum("bsd,df->bsf", x, w_up)
        h = _sigmoid(g) * u
        return torch.einsum("bsf,fd->bsd", h, w_down)

    x = A_x
    xn = _layernorm(x, axis=-1)
    return x + _A_ref(xn, A_k_cache, A_v_cache, A_wq, A_wo) + _B_ref(xn, B_w_gate, B_w_up, B_w_down)
```

```asm
; @launch grid=(256,1,1) block=(384,1,1) lds=136640
.amdgcn_target "amdgcn-amd-amdhsa--gfx950"
.text
.globl parallel_sum__sliding_block_cached__glu_gated_glu__decode_kernel
.p2align 8
.type parallel_sum__sliding_block_cached__glu_gated_glu__decode_kernel,@function
parallel_sum__sliding_block_cached__glu_gated_glu__decode_kernel:
    s_cmp_ge_u32 s2, 256
    s_cbranch_scc1 L_end
    s_load_dwordx16 s[4:19], s[0:1], 0
    s_load_dwordx8 s[20:27], s[0:1], 64
    v_and_b32 v1, 63, v0
    v_lshrrev_b32 v2, 6, v0
    s_and_b32 s28, s2, 7
    s_lshr_b32 s29, s2, 3
    v_readfirstlane_b32 s30, v2
    s_lshr_b32 s75, s29, 4
    s_lshl_b32 s75, s75, 3
    s_add_u32 s75, s75, s28
    s_lshl_b32 s75, s75, 23
    s_and_b32 s76, s29, 15
    s_lshl_b32 s76, s76, 16
    s_add_u32 s80, s75, s76
    s_add_u32 s80, s80, 0x700000
    s_mul_i32 s81, s2, 5
    s_lshr_b32 s75, s2, 4
    s_add_u32 s81, s81, s75
    s_movk_i32 s73, 0xfc00
    s_lshl_b32 s75, s28, 2
    s_mul_i32 s76, s28, 3
    s_add_u32 s76, s76, 4
    s_cmp_lt_u32 s28, 4
    s_cselect_b32 s57, s75, s76
    s_cselect_b32 s56, 0, 8
    s_cselect_b32 s59, 32, 24
    s_cselect_b32 s3, 0, 8
    s_cmp_eq_u32 s30, 4
    s_cbranch_scc1 L_loader
    s_cmp_eq_u32 s30, 5
    s_cbranch_scc0 L_compute
L_comm:
    s_setprio 3
    v_lshrrev_b32 v2, 5, v1
    v_lshlrev_b32 v2, 10, v2
    v_and_b32 v3, 31, v1
    v_lshl_add_u32 v72, v3, 5, v2
    v_lshrrev_b32 v2, 2, v1
    v_lshlrev_b32 v2, 13, v2
    v_bfe_u32 v3, v1, 4, 1
    v_lshlrev_b32 v3, 1, v3
    v_and_b32 v73, 3, v1
    v_xor_b32 v3, v3, v73
    v_lshl_add_u32 v73, v3, 4, v2
    s_and_b32 s75, s29, 1
    s_lshl_b32 s75, s75, 21
    s_lshl_b32 s76, s28, 4
    s_lshr_b32 s77, s29, 1
    s_add_u32 s77, s77, s3
    s_and_b32 s77, s77, 15
    s_add_u32 s76, s76, s77
    s_lshl_b32 s76, s76, 6
    s_add_u32 s78, s75, s76
    s_getreg_b32 s79, hwreg(HW_REG_XCC_ID, 0, 4)
    s_lshr_b32 s75, s29, 3
    s_lshl_b32 s63, s75, 8
    s_bfe_u32 s75, s29, 0x10002
    s_lshl_b32 s75, s75, 10
    s_add_u32 s63, s63, s75
    s_and_b32 s75, s29, 1
    s_lshl_b32 s75, s75, 7
    s_add_u32 s63, s63, s75
    s_bfe_u32 s75, s29, 0x10001
    s_lshl_b32 s75, s75, 3
    s_add_u32 s63, s63, s75
    v_and_b32 v63, 7, v1
    v_lshlrev_b32 v63, 4, v63
    s_waitcnt lgkmcnt(0)
    s_load_dword s31, s[26:27], 0
    s_mov_b32 s32, s4
    s_mov_b32 s33, s5
    s_mov_b32 s34, 0x800
    s_mov_b32 s35, 0x20000
    s_mov_b32 s36, s10
    s_mov_b32 s37, s11
    s_mov_b32 s38, 0x400000
    s_mov_b32 s39, 0x20000
    buffer_load_dwordx4 v[64:67], v72, s[32:35], 0 offen
    buffer_load_dwordx4 v[68:71], v72, s[32:35], 0 offen offset:16
    buffer_load_dwordx2 v[60:61], v63, s[32:35], s63 offen
    s_getpc_b64 s[64:65]
L_pcref:
    s_sub_u32 s64, s64, L_pcref-parallel_sum__sliding_block_cached__glu_gated_glu__decode_kernel
    s_subb_u32 s65, s65, 0
    s_mul_i32 s75, s29, 5
    v_add_u32 v2, s75, v1
    v_lshlrev_b32 v2, 7, v2
    s_mov_b32 s76, L_end-parallel_sum__sliding_block_cached__glu_gated_glu__decode_kernel
    v_min_u32 v2, s76, v2
    s_mov_b64 exec, 0x1f
    global_load_dword v246, v2, s[64:65]
    s_mov_b64 exec, -1
    s_mov_b32 m0, 98304
    s_add_u32 s75, s78, 0
    buffer_load_dwordx4 v73, s[36:39], s75 offen offset:0 nt lds
    s_add_u32 s75, s78, 130048
    buffer_load_dwordx4 v73, s[36:39], s75 offen offset:1024 nt lds
    s_add_u32 s75, s78, 260096
    buffer_load_dwordx4 v73, s[36:39], s75 offen offset:2048 nt lds
    s_add_u32 s75, s78, 390144
    buffer_load_dwordx4 v73, s[36:39], s75 offen offset:3072 nt lds
    s_mov_b32 m0, 102400
    s_add_u32 s75, s78, 524288
    buffer_load_dwordx4 v73, s[36:39], s75 offen offset:0 nt lds
    s_add_u32 s75, s78, 654336
    buffer_load_dwordx4 v73, s[36:39], s75 offen offset:1024 nt lds
    s_add_u32 s75, s78, 784384
    buffer_load_dwordx4 v73, s[36:39], s75 offen offset:2048 nt lds
    s_add_u32 s75, s78, 914432
    buffer_load_dwordx4 v73, s[36:39], s75 offen offset:3072 nt lds
    s_mov_b32 m0, 106496
    s_add_u32 s75, s78, 1048576
    buffer_load_dwordx4 v73, s[36:39], s75 offen offset:0 nt lds
    s_add_u32 s75, s78, 1178624
    buffer_load_dwordx4 v73, s[36:39], s75 offen offset:1024 nt lds
    s_add_u32 s75, s78, 1308672
    buffer_load_dwordx4 v73, s[36:39], s75 offen offset:2048 nt lds
    s_add_u32 s75, s78, 1438720
    buffer_load_dwordx4 v73, s[36:39], s75 offen offset:3072 nt lds
    s_mov_b32 m0, 110592
    s_add_u32 s75, s78, 1572864
    buffer_load_dwordx4 v73, s[36:39], s75 offen offset:0 nt lds
    s_add_u32 s75, s78, 1702912
    buffer_load_dwordx4 v73, s[36:39], s75 offen offset:1024 nt lds
    s_add_u32 s75, s78, 1832960
    buffer_load_dwordx4 v73, s[36:39], s75 offen offset:2048 nt lds
    s_add_u32 s75, s78, 1963008
    buffer_load_dwordx4 v73, s[36:39], s75 offen offset:3072 nt lds
    v_mov_b32 v4, 136576
    v_mov_b32 v6, 1
    s_mov_b32 s40, s22
    s_mov_b32 s41, s23
    s_mov_b32 s42, 0x800
    s_mov_b32 s43, 0x20000
    s_mov_b32 s68, s26
    s_mov_b32 s69, s27
    s_mov_b32 s70, 0x20000000
    s_mov_b32 s71, 0x20000
    s_barrier
    s_branch L_comm2
L_loader:
    s_setprio 3
    v_mov_b32 v4, 136576
    v_mov_b32 v5, 0
    v_lshlrev_b32 v2, 2, v1
    v_add_u32 v2, 136576, v2
    s_mov_b64 exec, 0xffff
    ds_write_b32 v2, v5
    s_mov_b64 exec, -1
    v_lshrrev_b32 v2, 3, v1
    v_mul_u32_u24 v2, 3584, v2
    v_bfe_u32 v3, v1, 1, 2
    v_lshrrev_b32 v10, 4, v1
    v_xor_b32 v3, v3, v10
    v_lshl_add_u32 v2, v3, 5, v2
    v_and_b32 v3, 1, v1
    v_lshl_add_u32 v8, v3, 4, v2
    s_and_b32 s79, s29, 7
    s_mul_i32 s79, s79, 229376
    s_lshr_b32 s75, s29, 3
    s_add_u32 s75, s75, s57
    s_lshl_b32 s75, s75, 7
    s_add_u32 s79, s79, s75
    v_lshrrev_b32 v2, 4, v1
    v_and_b32 v3, 15, v1
    v_xor_b32 v3, v3, v2
    v_lshlrev_b32 v3, 4, v3
    v_lshl_add_u32 v12, v2, 8, v3
    v_xor_b32 v13, 64, v12
    v_xor_b32 v14, 128, v12
    v_xor_b32 v15, 192, v12
    v_bfe_u32 v3, v1, 1, 3
    v_xor_b32 v3, v3, v2
    v_lshlrev_b32 v3, 5, v3
    v_lshl_add_u32 v3, v2, 8, v3
    v_and_b32 v2, 1, v1
    v_lshl_add_u32 v6, v2, 4, v3
    v_xor_b32 v7, 128, v6
    v_lshlrev_b32 v9, 4, v1
    s_lshl_b32 s78, s28, 19
    s_lshl_b32 s75, s29, 14
    s_add_u32 s78, s78, s75
    s_lshl_b32 s75, s57, 3
    s_add_u32 s75, s75, s29
    s_sub_u32 s75, s75, s56
    s_lshl_b32 s76, s75, 13
    s_waitcnt lgkmcnt(0)
    s_mov_b32 s44, s16
    s_mov_b32 s45, s17
    s_mov_b32 s46, 0x1c0000
    s_mov_b32 s47, 0x20000
    s_mov_b32 s48, s18
    s_mov_b32 s49, s19
    s_mov_b32 s50, 0x1c0000
    s_mov_b32 s51, 0x20000
    s_mov_b32 s32, s6
    s_mov_b32 s33, s7
    s_mov_b32 s34, 0x8000000
    s_mov_b32 s35, 0x20000
    s_mov_b32 s36, s8
    s_mov_b32 s37, s9
    s_mov_b32 s38, 0x8000000
    s_mov_b32 s39, 0x20000
    s_mov_b32 s40, s12
    s_mov_b32 s41, s13
    s_mov_b32 s42, 0x400000
    s_mov_b32 s43, 0x20000
    s_mov_b32 s52, s20
    s_mov_b32 s53, s21
    s_mov_b32 s54, 0x1c0000
    s_mov_b32 s55, 0x20000
    s_barrier
    s_cmp_ge_u32 s29, s59
    s_cbranch_scc1 Lnogu_63
    s_mov_b32 m0, 114688
    s_add_u32 s75, s79, 0
    buffer_load_dwordx4 v8, s[44:47], s75 offen offset:0 nt lds
    s_add_u32 s75, s79, 27648
    buffer_load_dwordx4 v8, s[44:47], s75 offen offset:1024 nt lds
    s_add_u32 s75, s79, 55296
    buffer_load_dwordx4 v8, s[44:47], s75 offen offset:2048 nt lds
    s_add_u32 s75, s79, 82944
    buffer_load_dwordx4 v8, s[44:47], s75 offen offset:3072 nt lds
    s_mov_b32 m0, 118784
    s_add_u32 s75, s79, 114688
    buffer_load_dwordx4 v8, s[44:47], s75 offen offset:0 nt lds
    s_add_u32 s75, s79, 142336
    buffer_load_dwordx4 v8, s[44:47], s75 offen offset:1024 nt lds
    s_add_u32 s75, s79, 169984
    buffer_load_dwordx4 v8, s[44:47], s75 offen offset:2048 nt lds
    s_add_u32 s75, s79, 197632
    buffer_load_dwordx4 v8, s[44:47], s75 offen offset:3072 nt lds
    s_mov_b32 m0, 122880
    s_add_u32 s75, s79, 0
    buffer_load_dwordx4 v8, s[48:51], s75 offen offset:0 nt lds
    s_add_u32 s75, s79, 27648
    buffer_load_dwordx4 v8, s[48:51], s75 offen offset:1024 nt lds
    s_add_u32 s75, s79, 55296
    buffer_load_dwordx4 v8, s[48:51], s75 offen offset:2048 nt lds
    s_add_u32 s75, s79, 82944
    buffer_load_dwordx4 v8, s[48:51], s75 offen offset:3072 nt lds
    s_mov_b32 m0, 126976
    s_add_u32 s75, s79, 114688
    buffer_load_dwordx4 v8, s[48:51], s75 offen offset:0 nt lds
    s_add_u32 s75, s79, 142336
    buffer_load_dwordx4 v8, s[48:51], s75 offen offset:1024 nt lds
    s_add_u32 s75, s79, 169984
    buffer_load_dwordx4 v8, s[48:51], s75 offen offset:2048 nt lds
    s_add_u32 s75, s79, 197632
    buffer_load_dwordx4 v8, s[48:51], s75 offen offset:3072 nt lds
Lnogu_63:
    s_add_u32 s75, s81, 0
    s_and_b32 s75, s75, 15
    s_lshl_b32 s75, s75, 12
    s_add_u32 s75, s75, s80
    s_mov_b32 m0, 0
    s_nop 0
    buffer_load_dwordx4 v12, s[32:35], s75 offen offset:0 nt lds
    buffer_load_dwordx4 v13, s[32:35], s75 offen offset:1024 nt lds
    buffer_load_dwordx4 v14, s[32:35], s75 offen offset:2048 nt lds
    buffer_load_dwordx4 v15, s[32:35], s75 offen offset:3072 nt lds
    s_add_u32 s75, s81, 1
    s_and_b32 s75, s75, 15
    s_lshl_b32 s75, s75, 12
    s_add_u32 s75, s75, s80
    s_mov_b32 m0, 4096
    s_nop 0
    buffer_load_dwordx4 v12, s[32:35], s75 offen offset:0 nt lds
    buffer_load_dwordx4 v13, s[32:35], s75 offen offset:1024 nt lds
    buffer_load_dwordx4 v14, s[32:35], s75 offen offset:2048 nt lds
    buffer_load_dwordx4 v15, s[32:35], s75 offen offset:3072 nt lds
    s_add_u32 s75, s81, 2
    s_and_b32 s75, s75, 15
    s_lshl_b32 s75, s75, 12
    s_add_u32 s75, s75, s80
    s_mov_b32 m0, 8192
    s_nop 0
    buffer_load_dwordx4 v12, s[32:35], s75 offen offset:0 nt lds
    buffer_load_dwordx4 v13, s[32:35], s75 offen offset:1024 nt lds
    buffer_load_dwordx4 v14, s[32:35], s75 offen offset:2048 nt lds
    buffer_load_dwordx4 v15, s[32:35], s75 offen offset:3072 nt lds
    s_add_u32 s75, s81, 3
    s_and_b32 s75, s75, 15
    s_lshl_b32 s75, s75, 12
    s_add_u32 s75, s75, s80
    s_mov_b32 m0, 12288
    s_nop 0
    buffer_load_dwordx4 v12, s[32:35], s75 offen offset:0 nt lds
    buffer_load_dwordx4 v13, s[32:35], s75 offen offset:1024 nt lds
    buffer_load_dwordx4 v14, s[32:35], s75 offen offset:2048 nt lds
    buffer_load_dwordx4 v15, s[32:35], s75 offen offset:3072 nt lds
    s_add_u32 s75, s81, 4
    s_and_b32 s75, s75, 15
    s_lshl_b32 s75, s75, 12
    s_add_u32 s75, s75, s80
    s_mov_b32 m0, 16384
    s_nop 0
    buffer_load_dwordx4 v12, s[32:35], s75 offen offset:0 nt lds
    buffer_load_dwordx4 v13, s[32:35], s75 offen offset:1024 nt lds
    buffer_load_dwordx4 v14, s[32:35], s75 offen offset:2048 nt lds
    buffer_load_dwordx4 v15, s[32:35], s75 offen offset:3072 nt lds
    s_waitcnt vmcnt(32)
    s_add_u32 s75, s81, 5
    s_and_b32 s75, s75, 15
    s_lshl_b32 s75, s75, 12
    s_add_u32 s75, s75, s80
    s_mov_b32 m0, 20480
    s_nop 0
    buffer_load_dwordx4 v12, s[32:35], s75 offen offset:0 nt lds
    buffer_load_dwordx4 v13, s[32:35], s75 offen offset:1024 nt lds
    buffer_load_dwordx4 v14, s[32:35], s75 offen offset:2048 nt lds
    buffer_load_dwordx4 v15, s[32:35], s75 offen offset:3072 nt lds
    s_waitcnt vmcnt(32)
    v_mov_b32 v5, 8
    s_mov_b64 exec, 1
    ds_write_b32 v4, v5 offset:20
    s_mov_b64 exec, -1
    s_add_u32 s75, s81, 6
    s_and_b32 s75, s75, 15
    s_lshl_b32 s75, s75, 12
    s_add_u32 s75, s75, s80
    s_mov_b32 m0, 24576
    s_nop 0
    buffer_load_dwordx4 v12, s[32:35], s75 offen offset:0 nt lds
    buffer_load_dwordx4 v13, s[32:35], s75 offen offset:1024 nt lds
    buffer_load_dwordx4 v14, s[32:35], s75 offen offset:2048 nt lds
    buffer_load_dwordx4 v15, s[32:35], s75 offen offset:3072 nt lds
    s_waitcnt vmcnt(32)
    s_add_u32 s75, s81, 7
    s_and_b32 s75, s75, 15
    s_lshl_b32 s75, s75, 12
    s_add_u32 s75, s75, s80
    s_mov_b32 m0, 28672
    s_nop 0
    buffer_load_dwordx4 v12, s[32:35], s75 offen offset:0 nt lds
    buffer_load_dwordx4 v13, s[32:35], s75 offen offset:1024 nt lds
    buffer_load_dwordx4 v14, s[32:35], s75 offen offset:2048 nt lds
    buffer_load_dwordx4 v15, s[32:35], s75 offen offset:3072 nt lds
    s_waitcnt vmcnt(32)
    v_mov_b32 v5, 16
    s_mov_b64 exec, 1
    ds_write_b32 v4, v5 offset:20
    s_mov_b64 exec, -1
    s_add_u32 s75, s81, 8
    s_and_b32 s75, s75, 15
    s_lshl_b32 s75, s75, 12
    s_add_u32 s75, s75, s80
    s_mov_b32 m0, 32768
    s_nop 0
    buffer_load_dwordx4 v12, s[32:35], s75 offen offset:0 nt lds
    buffer_load_dwordx4 v13, s[32:35], s75 offen offset:1024 nt lds
    buffer_load_dwordx4 v14, s[32:35], s75 offen offset:2048 nt lds
    buffer_load_dwordx4 v15, s[32:35], s75 offen offset:3072 nt lds
    s_waitcnt vmcnt(32)
    s_add_u32 s75, s81, 9
    s_and_b32 s75, s75, 15
    s_lshl_b32 s75, s75, 12
    s_add_u32 s75, s75, s80
    s_mov_b32 m0, 36864
    s_nop 0
    buffer_load_dwordx4 v12, s[32:35], s75 offen offset:0 nt lds
    buffer_load_dwordx4 v13, s[32:35], s75 offen offset:1024 nt lds
    buffer_load_dwordx4 v14, s[32:35], s75 offen offset:2048 nt lds
    buffer_load_dwordx4 v15, s[32:35], s75 offen offset:3072 nt lds
    s_waitcnt vmcnt(32)
    v_mov_b32 v5, 24
    s_mov_b64 exec, 1
    ds_write_b32 v4, v5 offset:20
    s_mov_b64 exec, -1
    s_add_u32 s75, s81, 10
    s_and_b32 s75, s75, 15
    s_lshl_b32 s75, s75, 12
    s_add_u32 s75, s75, s80
    s_mov_b32 m0, 40960
    s_nop 0
    buffer_load_dwordx4 v12, s[32:35], s75 offen offset:0 nt lds
    buffer_load_dwordx4 v13, s[32:35], s75 offen offset:1024 nt lds
    buffer_load_dwordx4 v14, s[32:35], s75 offen offset:2048 nt lds
    buffer_load_dwordx4 v15, s[32:35], s75 offen offset:3072 nt lds
    s_waitcnt vmcnt(32)
    s_add_u32 s75, s81, 11
    s_and_b32 s75, s75, 15
    s_lshl_b32 s75, s75, 12
    s_add_u32 s75, s75, s80
    s_mov_b32 m0, 45056
    s_nop 0
    buffer_load_dwordx4 v12, s[32:35], s75 offen offset:0 nt lds
    buffer_load_dwordx4 v13, s[32:35], s75 offen offset:1024 nt lds
    buffer_load_dwordx4 v14, s[32:35], s75 offen offset:2048 nt lds
    buffer_load_dwordx4 v15, s[32:35], s75 offen offset:3072 nt lds
    s_waitcnt vmcnt(32)
    v_mov_b32 v5, 32
    s_mov_b64 exec, 1
    ds_write_b32 v4, v5 offset:20
    s_mov_b64 exec, -1
    s_add_u32 s75, s81, 12
    s_and_b32 s75, s75, 15
    s_lshl_b32 s75, s75, 12
    s_add_u32 s75, s75, s80
    s_mov_b32 m0, 49152
    s_nop 0
    buffer_load_dwordx4 v12, s[32:35], s75 offen offset:0 nt lds
    buffer_load_dwordx4 v13, s[32:35], s75 offen offset:1024 nt lds
    buffer_load_dwordx4 v14, s[32:35], s75 offen offset:2048 nt lds
    buffer_load_dwordx4 v15, s[32:35], s75 offen offset:3072 nt lds
    s_waitcnt vmcnt(32)
    s_add_u32 s75, s81, 13
    s_and_b32 s75, s75, 15
    s_lshl_b32 s75, s75, 12
    s_add_u32 s75, s75, s80
    s_mov_b32 m0, 53248
    s_nop 0
    buffer_load_dwordx4 v12, s[32:35], s75 offen offset:0 nt lds
    buffer_load_dwordx4 v13, s[32:35], s75 offen offset:1024 nt lds
    buffer_load_dwordx4 v14, s[32:35], s75 offen offset:2048 nt lds
    buffer_load_dwordx4 v15, s[32:35], s75 offen offset:3072 nt lds
    s_waitcnt vmcnt(32)
    v_mov_b32 v5, 40
    s_mov_b64 exec, 1
    ds_write_b32 v4, v5 offset:20
    s_mov_b64 exec, -1
    s_add_u32 s75, s81, 14
    s_and_b32 s75, s75, 15
    s_lshl_b32 s75, s75, 12
    s_add_u32 s75, s75, s80
    s_mov_b32 m0, 57344
    s_nop 0
    buffer_load_dwordx4 v12, s[32:35], s75 offen offset:0 nt lds
    buffer_load_dwordx4 v13, s[32:35], s75 offen offset:1024 nt lds
    buffer_load_dwordx4 v14, s[32:35], s75 offen offset:2048 nt lds
    buffer_load_dwordx4 v15, s[32:35], s75 offen offset:3072 nt lds
    s_waitcnt vmcnt(32)
    s_add_u32 s75, s81, 15
    s_and_b32 s75, s75, 15
    s_lshl_b32 s75, s75, 12
    s_add_u32 s75, s75, s80
    s_mov_b32 m0, 61440
    s_nop 0
    buffer_load_dwordx4 v12, s[32:35], s75 offen offset:0 nt lds
    buffer_load_dwordx4 v13, s[32:35], s75 offen offset:1024 nt lds
    buffer_load_dwordx4 v14, s[32:35], s75 offen offset:2048 nt lds
    buffer_load_dwordx4 v15, s[32:35], s75 offen offset:3072 nt lds
    s_waitcnt vmcnt(32)
    v_mov_b32 v5, 48
    s_mov_b64 exec, 1
    ds_write_b32 v4, v5 offset:20
    s_mov_b64 exec, -1
    s_add_u32 s75, s81, 0
    s_and_b32 s75, s75, 15
    s_lshl_b32 s75, s75, 12
    s_add_u32 s75, s75, s80
    s_mov_b32 m0, 65536
    s_nop 0
    buffer_load_dwordx4 v6, s[36:39], s75 offen offset:0 nt lds
    buffer_load_dwordx4 v7, s[36:39], s75 offen offset:1024 nt lds
    buffer_load_dwordx4 v6, s[36:39], s75 offen offset:2048 nt lds
    buffer_load_dwordx4 v7, s[36:39], s75 offen offset:3072 nt lds
    s_waitcnt vmcnt(32)
    s_add_u32 s75, s81, 1
    s_and_b32 s75, s75, 15
    s_lshl_b32 s75, s75, 12
    s_add_u32 s75, s75, s80
    s_mov_b32 m0, 69632
    s_nop 0
    buffer_load_dwordx4 v6, s[36:39], s75 offen offset:0 nt lds
    buffer_load_dwordx4 v7, s[36:39], s75 offen offset:1024 nt lds
    buffer_load_dwordx4 v6, s[36:39], s75 offen offset:2048 nt lds
    buffer_load_dwordx4 v7, s[36:39], s75 offen offset:3072 nt lds
    s_waitcnt vmcnt(32)
    v_mov_b32 v5, 56
    s_mov_b64 exec, 1
    ds_write_b32 v4, v5 offset:20
    s_mov_b64 exec, -1
    s_add_u32 s75, s81, 2
    s_and_b32 s75, s75, 15
    s_lshl_b32 s75, s75, 12
    s_add_u32 s75, s75, s80
    s_mov_b32 m0, 73728
    s_nop 0
    buffer_load_dwordx4 v6, s[36:39], s75 offen offset:0 nt lds
    buffer_load_dwordx4 v7, s[36:39], s75 offen offset:1024 nt lds
    buffer_load_dwordx4 v6, s[36:39], s75 offen offset:2048 nt lds
    buffer_load_dwordx4 v7, s[36:39], s75 offen offset:3072 nt lds
    s_waitcnt vmcnt(32)
    s_add_u32 s75, s81, 3
    s_and_b32 s75, s75, 15
    s_lshl_b32 s75, s75, 12
    s_add_u32 s75, s75, s80
    s_mov_b32 m0, 77824
    s_nop 0
    buffer_load_dwordx4 v6, s[36:39], s75 offen offset:0 nt lds
    buffer_load_dwordx4 v7, s[36:39], s75 offen offset:1024 nt lds
    buffer_load_dwordx4 v6, s[36:39], s75 offen offset:2048 nt lds
    buffer_load_dwordx4 v7, s[36:39], s75 offen offset:3072 nt lds
    s_waitcnt vmcnt(32)
    v_mov_b32 v5, 64
    s_mov_b64 exec, 1
    ds_write_b32 v4, v5 offset:20
    s_mov_b64 exec, -1
    s_add_u32 s75, s81, 4
    s_and_b32 s75, s75, 15
    s_lshl_b32 s75, s75, 12
    s_add_u32 s75, s75, s80
    s_mov_b32 m0, 81920
    s_nop 0
    buffer_load_dwordx4 v6, s[36:39], s75 offen offset:0 nt lds
    buffer_load_dwordx4 v7, s[36:39], s75 offen offset:1024 nt lds
    buffer_load_dwordx4 v6, s[36:39], s75 offen offset:2048 nt lds
    buffer_load_dwordx4 v7, s[36:39], s75 offen offset:3072 nt lds
    s_waitcnt vmcnt(32)
    s_add_u32 s75, s81, 5
    s_and_b32 s75, s75, 15
    s_lshl_b32 s75, s75, 12
    s_add_u32 s75, s75, s80
    s_mov_b32 m0, 86016
    s_nop 0
    buffer_load_dwordx4 v6, s[36:39], s75 offen offset:0 nt lds
    buffer_load_dwordx4 v7, s[36:39], s75 offen offset:1024 nt lds
    buffer_load_dwordx4 v6, s[36:39], s75 offen offset:2048 nt lds
    buffer_load_dwordx4 v7, s[36:39], s75 offen offset:3072 nt lds
    s_waitcnt vmcnt(32)
    v_mov_b32 v5, 72
    s_mov_b64 exec, 1
    ds_write_b32 v4, v5 offset:20
    s_mov_b64 exec, -1
    s_add_u32 s75, s81, 6
    s_and_b32 s75, s75, 15
    s_lshl_b32 s75, s75, 12
    s_add_u32 s75, s75, s80
    s_mov_b32 m0, 90112
    s_nop 0
    buffer_load_dwordx4 v6, s[36:39], s75 offen offset:0 nt lds
    buffer_load_dwordx4 v7, s[36:39], s75 offen offset:1024 nt lds
    buffer_load_dwordx4 v6, s[36:39], s75 offen offset:2048 nt lds
    buffer_load_dwordx4 v7, s[36:39], s75 offen offset:3072 nt lds
    s_waitcnt vmcnt(32)
    s_add_u32 s75, s81, 7
    s_and_b32 s75, s75, 15
    s_lshl_b32 s75, s75, 12
    s_add_u32 s75, s75, s80
    s_mov_b32 m0, 94208
    s_nop 0
    buffer_load_dwordx4 v6, s[36:39], s75 offen offset:0 nt lds
    buffer_load_dwordx4 v7, s[36:39], s75 offen offset:1024 nt lds
    buffer_load_dwordx4 v6, s[36:39], s75 offen offset:2048 nt lds
    buffer_load_dwordx4 v7, s[36:39], s75 offen offset:3072 nt lds
    s_mov_b32 s74, 1048576
Lw_64:
    ds_read_b32 v10, v4 offset:4
    s_waitcnt lgkmcnt(0)
    v_readfirstlane_b32 s75, v10
    s_nop 0
    s_cmp_ge_u32 s75, 1
    s_cbranch_scc1 Lwd_65
    s_sub_u32 s74, s74, 1
    s_cbranch_scc0 Lw_64
    s_branch L_end
Lwd_65:
    s_cmp_ge_u32 s29, s59
    s_cbranch_scc1 Lg_66
    s_mov_b32 s74, 1048576
Lw_67:
    ds_read_b32 v10, v4 offset:32
    s_waitcnt lgkmcnt(0)
    v_readfirstlane_b32 s75, v10
    s_nop 0
    s_cmp_ge_u32 s75, 4
    s_cbranch_scc1 Lwd_68
    s_sub_u32 s74, s74, 1
    s_cbranch_scc0 Lw_67
    s_branch L_end
Lwd_68:
Lg_66:
    s_waitcnt vmcnt(32)
    v_mov_b32 v5, 80
    s_mov_b64 exec, 1
    ds_write_b32 v4, v5 offset:20
    s_mov_b64 exec, -1
    s_add_u32 s75, s81, 8
    s_and_b32 s75, s75, 15
    s_lshl_b32 s75, s75, 12
    s_add_u32 s75, s75, s80
    s_mov_b32 m0, 98304
    s_nop 0
    buffer_load_dwordx4 v6, s[36:39], s75 offen offset:0 nt lds
    buffer_load_dwordx4 v7, s[36:39], s75 offen offset:1024 nt lds
    buffer_load_dwordx4 v6, s[36:39], s75 offen offset:2048 nt lds
    buffer_load_dwordx4 v7, s[36:39], s75 offen offset:3072 nt lds
    s_waitcnt vmcnt(32)
    s_add_u32 s75, s81, 9
    s_and_b32 s75, s75, 15
    s_lshl_b32 s75, s75, 12
    s_add_u32 s75, s75, s80
    s_mov_b32 m0, 102400
    s_nop 0
    buffer_load_dwordx4 v6, s[36:39], s75 offen offset:0 nt lds
    buffer_load_dwordx4 v7, s[36:39], s75 offen offset:1024 nt lds
    buffer_load_dwordx4 v6, s[36:39], s75 offen offset:2048 nt lds
    buffer_load_dwordx4 v7, s[36:39], s75 offen offset:3072 nt lds
    s_waitcnt vmcnt(32)
    v_mov_b32 v5, 88
    s_mov_b64 exec, 1
    ds_write_b32 v4, v5 offset:20
    s_mov_b64 exec, -1
    s_add_u32 s75, s81, 10
    s_and_b32 s75, s75, 15
    s_lshl_b32 s75, s75, 12
    s_add_u32 s75, s75, s80
    s_mov_b32 m0, 106496
    s_nop 0
    buffer_load_dwordx4 v6, s[36:39], s75 offen offset:0 nt lds
    buffer_load_dwordx4 v7, s[36:39], s75 offen offset:1024 nt lds
    buffer_load_dwordx4 v6, s[36:39], s75 offen offset:2048 nt lds
    buffer_load_dwordx4 v7, s[36:39], s75 offen offset:3072 nt lds
    s_waitcnt vmcnt(32)
    s_add_u32 s75, s81, 11
    s_and_b32 s75, s75, 15
    s_lshl_b32 s75, s75, 12
    s_add_u32 s75, s75, s80
    s_mov_b32 m0, 110592
    s_nop 0
    buffer_load_dwordx4 v6, s[36:39], s75 offen offset:0 nt lds
    buffer_load_dwordx4 v7, s[36:39], s75 offen offset:1024 nt lds
    buffer_load_dwordx4 v6, s[36:39], s75 offen offset:2048 nt lds
    buffer_load_dwordx4 v7, s[36:39], s75 offen offset:3072 nt lds
    s_waitcnt vmcnt(32)
    v_mov_b32 v5, 96
    s_mov_b64 exec, 1
    ds_write_b32 v4, v5 offset:20
    s_mov_b64 exec, -1
    s_add_u32 s75, s81, 12
    s_and_b32 s75, s75, 15
    s_lshl_b32 s75, s75, 12
    s_add_u32 s75, s75, s80
    s_mov_b32 m0, 114688
    s_nop 0
    buffer_load_dwordx4 v6, s[36:39], s75 offen offset:0 nt lds
    buffer_load_dwordx4 v7, s[36:39], s75 offen offset:1024 nt lds
    buffer_load_dwordx4 v6, s[36:39], s75 offen offset:2048 nt lds
    buffer_load_dwordx4 v7, s[36:39], s75 offen offset:3072 nt lds
    s_waitcnt vmcnt(32)
    s_add_u32 s75, s81, 13
    s_and_b32 s75, s75, 15
    s_lshl_b32 s75, s75, 12
    s_add_u32 s75, s75, s80
    s_mov_b32 m0, 118784
    s_nop 0
    buffer_load_dwordx4 v6, s[36:39], s75 offen offset:0 nt lds
    buffer_load_dwordx4 v7, s[36:39], s75 offen offset:1024 nt lds
    buffer_load_dwordx4 v6, s[36:39], s75 offen offset:2048 nt lds
    buffer_load_dwordx4 v7, s[36:39], s75 offen offset:3072 nt lds
    s_waitcnt vmcnt(32)
    v_mov_b32 v5, 104
    s_mov_b64 exec, 1
    ds_write_b32 v4, v5 offset:20
    s_mov_b64 exec, -1
    s_add_u32 s75, s81, 14
    s_and_b32 s75, s75, 15
    s_lshl_b32 s75, s75, 12
    s_add_u32 s75, s75, s80
    s_mov_b32 m0, 122880
    s_nop 0
    buffer_load_dwordx4 v6, s[36:39], s75 offen offset:0 nt lds
    buffer_load_dwordx4 v7, s[36:39], s75 offen offset:1024 nt lds
    buffer_load_dwordx4 v6, s[36:39], s75 offen offset:2048 nt lds
    buffer_load_dwordx4 v7, s[36:39], s75 offen offset:3072 nt lds
    s_waitcnt vmcnt(32)
    s_add_u32 s75, s81, 15
    s_and_b32 s75, s75, 15
    s_lshl_b32 s75, s75, 12
    s_add_u32 s75, s75, s80
    s_mov_b32 m0, 126976
    s_nop 0
    buffer_load_dwordx4 v6, s[36:39], s75 offen offset:0 nt lds
    buffer_load_dwordx4 v7, s[36:39], s75 offen offset:1024 nt lds
    buffer_load_dwordx4 v6, s[36:39], s75 offen offset:2048 nt lds
    buffer_load_dwordx4 v7, s[36:39], s75 offen offset:3072 nt lds
    s_mov_b32 s74, 1048576
Lw_69:
    ds_read_b32 v10, v4 offset:44
    s_waitcnt lgkmcnt(0)
    v_readfirstlane_b32 s75, v10
    s_nop 0
    s_cmp_ge_u32 s75, 4
    s_cbranch_scc1 Lwd_70
    s_sub_u32 s74, s74, 1
    s_cbranch_scc0 Lw_69
    s_branch L_end
Lwd_70:
    s_waitcnt vmcnt(32)
    v_mov_b32 v5, 112
    s_mov_b64 exec, 1
    ds_write_b32 v4, v5 offset:20
    s_mov_b64 exec, -1
    s_add_u32 s77, s81, 0
    s_and_b32 s77, s77, 3
    s_lshl_b32 s77, s77, 12
    s_add_u32 s75, s78, s77
    s_add_u32 s77, s77, 0
    s_mov_b32 m0, s77
    s_nop 0
    buffer_load_dwordx4 v9, s[40:43], s75 offen offset:0 nt lds
    buffer_load_dwordx4 v9, s[40:43], s75 offen offset:1024 nt lds
    buffer_load_dwordx4 v9, s[40:43], s75 offen offset:2048 nt lds
    buffer_load_dwordx4 v9, s[40:43], s75 offen offset:3072 nt lds
    s_waitcnt vmcnt(32)
    s_add_u32 s77, s81, 1
    s_and_b32 s77, s77, 3
    s_lshl_b32 s77, s77, 12
    s_add_u32 s75, s78, s77
    s_add_u32 s77, s77, 0
    s_mov_b32 m0, s77
    s_nop 0
    buffer_load_dwordx4 v9, s[40:43], s75 offen offset:0 nt lds
    buffer_load_dwordx4 v9, s[40:43], s75 offen offset:1024 nt lds
    buffer_load_dwordx4 v9, s[40:43], s75 offen offset:2048 nt lds
    buffer_load_dwordx4 v9, s[40:43], s75 offen offset:3072 nt lds
    s_waitcnt vmcnt(32)
    v_mov_b32 v5, 120
    s_mov_b64 exec, 1
    ds_write_b32 v4, v5 offset:20
    s_mov_b64 exec, -1
    s_add_u32 s77, s81, 2
    s_and_b32 s77, s77, 3
    s_lshl_b32 s77, s77, 12
    s_add_u32 s75, s78, s77
    s_add_u32 s77, s77, 0
    s_mov_b32 m0, s77
    s_nop 0
    buffer_load_dwordx4 v9, s[40:43], s75 offen offset:0 nt lds
    buffer_load_dwordx4 v9, s[40:43], s75 offen offset:1024 nt lds
    buffer_load_dwordx4 v9, s[40:43], s75 offen offset:2048 nt lds
    buffer_load_dwordx4 v9, s[40:43], s75 offen offset:3072 nt lds
    s_waitcnt vmcnt(32)
    s_add_u32 s77, s81, 3
    s_and_b32 s77, s77, 3
    s_lshl_b32 s77, s77, 12
    s_add_u32 s75, s78, s77
    s_add_u32 s77, s77, 0
    s_mov_b32 m0, s77
    s_nop 0
    buffer_load_dwordx4 v9, s[40:43], s75 offen offset:0 nt lds
    buffer_load_dwordx4 v9, s[40:43], s75 offen offset:1024 nt lds
    buffer_load_dwordx4 v9, s[40:43], s75 offen offset:2048 nt lds
    buffer_load_dwordx4 v9, s[40:43], s75 offen offset:3072 nt lds
    s_cmp_lt_u32 s29, s56
    s_cbranch_scc1 L_loader_nf
    s_waitcnt vmcnt(32)
    v_mov_b32 v5, 128
    s_mov_b64 exec, 1
    ds_write_b32 v4, v5 offset:20
    s_mov_b64 exec, -1
    s_add_u32 s77, s81, 0
    s_and_b32 s77, s77, 1
    s_lshl_b32 s77, s77, 12
    s_add_u32 s75, s76, s77
    s_add_u32 s77, s77, 16384
    s_mov_b32 m0, s77
    s_nop 0
    buffer_load_dwordx4 v9, s[52:55], s75 offen offset:0 nt lds
    buffer_load_dwordx4 v9, s[52:55], s75 offen offset:1024 nt lds
    buffer_load_dwordx4 v9, s[52:55], s75 offen offset:2048 nt lds
    buffer_load_dwordx4 v9, s[52:55], s75 offen offset:3072 nt lds
    s_waitcnt vmcnt(32)
    s_add_u32 s77, s81, 1
    s_and_b32 s77, s77, 1
    s_lshl_b32 s77, s77, 12
    s_add_u32 s75, s76, s77
    s_add_u32 s77, s77, 16384
    s_mov_b32 m0, s77
    s_nop 0
    buffer_load_dwordx4 v9, s[52:55], s75 offen offset:0 nt lds
    buffer_load_dwordx4 v9, s[52:55], s75 offen offset:1024 nt lds
    buffer_load_dwordx4 v9, s[52:55], s75 offen offset:2048 nt lds
    buffer_load_dwordx4 v9, s[52:55], s75 offen offset:3072 nt lds
    s_waitcnt vmcnt(32)
    v_mov_b32 v5, 136
    s_mov_b64 exec, 1
    ds_write_b32 v4, v5 offset:20
    s_mov_b64 exec, -1
    s_waitcnt vmcnt(24)
    v_mov_b32 v5, 144
    s_mov_b64 exec, 1
    ds_write_b32 v4, v5 offset:20
    s_mov_b64 exec, -1
    s_waitcnt vmcnt(16)
    v_mov_b32 v5, 152
    s_mov_b64 exec, 1
    ds_write_b32 v4, v5 offset:20
    s_mov_b64 exec, -1
    s_waitcnt vmcnt(8)
    v_mov_b32 v5, 160
    s_mov_b64 exec, 1
    ds_write_b32 v4, v5 offset:20
    s_mov_b64 exec, -1
    s_waitcnt vmcnt(0)
    v_mov_b32 v5, 168
    s_mov_b64 exec, 1
    ds_write_b32 v4, v5 offset:20
    s_mov_b64 exec, -1
    s_endpgm
L_loader_nf:
    s_waitcnt vmcnt(32)
    v_mov_b32 v5, 128
    s_mov_b64 exec, 1
    ds_write_b32 v4, v5 offset:20
    s_mov_b64 exec, -1
    s_waitcnt vmcnt(24)
    v_mov_b32 v5, 136
    s_mov_b64 exec, 1
    ds_write_b32 v4, v5 offset:20
    s_mov_b64 exec, -1
    s_waitcnt vmcnt(16)
    v_mov_b32 v5, 144
    s_mov_b64 exec, 1
    ds_write_b32 v4, v5 offset:20
    s_mov_b64 exec, -1
    s_waitcnt vmcnt(8)
    v_mov_b32 v5, 152
    s_mov_b64 exec, 1
    ds_write_b32 v4, v5 offset:20
    s_mov_b64 exec, -1
    s_waitcnt vmcnt(0)
    v_mov_b32 v5, 160
    s_mov_b64 exec, 1
    ds_write_b32 v4, v5 offset:20
    s_mov_b64 exec, -1
    s_endpgm
L_comm2:
    s_lshl_b32 s75, s28, 14
    s_lshr_b32 s76, s29, 4
    s_lshl_b32 s76, s76, 13
    s_add_u32 s64, s75, s76
    s_lshl_b32 s65, s57, 3
    s_add_u32 s65, s65, s29
    s_sub_u32 s65, s65, s56
    s_lshl_b32 s65, s65, 10
    s_add_u32 s65, s65, 0xa0000
    s_lshl_b32 s75, s28, 5
    s_add_u32 s75, s75, s29
    s_lshl_b32 s66, s75, 11
    s_add_u32 s66, s66, 0x100000
    s_lshl_b32 s67, s75, 12
    s_add_u32 s67, s67, 0x200000
    s_lshl_b32 s62, s28, 7
    s_add_u32 s62, s62, 0x1000
    v_lshlrev_b32 v79, 7, v1
    s_add_u32 s75, s64, 0x10000
    buffer_load_dword v248, v79, s[68:71], s75 offen nt
    s_add_u32 s75, s62, 0x0
    s_mov_b64 exec, 0x1
    buffer_load_dword v249, v79, s[68:71], s75 offen nt
    s_mov_b64 exec, -1
    s_add_u32 s75, s65, 0x0
    s_mov_b64 exec, 0xff
    buffer_load_dword v250, v79, s[68:71], s75 offen nt
    s_mov_b64 exec, -1
    v_mov_b32 v7, 0x3ff
    s_waitcnt vmcnt(20)
    v_mov_b32 v56, v60
    v_mov_b32 v57, v61
    v_lshlrev_b32 v80, 16, v64
    v_and_b32 v81, 0xffff0000, v64
    v_lshlrev_b32 v82, 16, v65
    v_and_b32 v83, 0xffff0000, v65
    v_lshlrev_b32 v84, 16, v66
    v_and_b32 v85, 0xffff0000, v66
    v_lshlrev_b32 v86, 16, v67
    v_and_b32 v87, 0xffff0000, v67
    v_lshlrev_b32 v88, 16, v68
    v_and_b32 v89, 0xffff0000, v68
    v_lshlrev_b32 v90, 16, v69
    v_and_b32 v91, 0xffff0000, v69
    v_lshlrev_b32 v92, 16, v70
    v_and_b32 v93, 0xffff0000, v70
    v_lshlrev_b32 v94, 16, v71
    v_and_b32 v95, 0xffff0000, v71
    v_add_f32 v96, v80, v81
    v_add_f32 v97, v82, v83
    v_add_f32 v98, v84, v85
    v_add_f32 v99, v86, v87
    v_add_f32 v100, v88, v89
    v_add_f32 v101, v90, v91
    v_add_f32 v102, v92, v93
    v_add_f32 v103, v94, v95
    v_add_f32 v96, v96, v100
    v_add_f32 v97, v97, v101
    v_add_f32 v98, v98, v102
    v_add_f32 v99, v99, v103
    v_add_f32 v96, v96, v98
    v_add_f32 v97, v97, v99
    v_add_f32 v96, v96, v97
    s_nop 1
    v_add_f32_dpp v96, v96, v96 quad_perm:[1,0,3,2] row_mask:0xf bank_mask:0xf
    s_nop 1
    v_add_f32_dpp v96, v96, v96 quad_perm:[2,3,0,1] row_mask:0xf bank_mask:0xf
    s_nop 1
    v_add_f32_dpp v96, v96, v96 row_half_mirror row_mask:0xf bank_mask:0xf
    s_nop 1
    v_add_f32_dpp v96, v96, v96 row_mirror row_mask:0xf bank_mask:0xf
    v_mov_b32 v97, v96
    s_nop 1
    v_permlane16_swap_b32 v96, v97
    v_add_f32 v96, v96, v97
    v_mul_f32 v104, 0x3b000000, v96
    v_cvt_pk_bf16_f32 v105, v104, v104
    v_lshlrev_b32 v105, 16, v105
    v_sub_f32 v108, v80, v104
    v_sub_f32 v109, v81, v104
    v_sub_f32 v110, v82, v104
    v_sub_f32 v111, v83, v104
    v_sub_f32 v112, v84, v104
    v_sub_f32 v113, v85, v104
    v_sub_f32 v114, v86, v104
    v_sub_f32 v115, v87, v104
    v_sub_f32 v116, v88, v104
    v_sub_f32 v117, v89, v104
    v_sub_f32 v118, v90, v104
    v_sub_f32 v119, v91, v104
    v_sub_f32 v120, v92, v104
    v_sub_f32 v121, v93, v104
    v_sub_f32 v122, v94, v104
    v_sub_f32 v123, v95, v104
    v_mul_f32 v96, v108, v108
    v_mul_f32 v97, v109, v109
    v_mul_f32 v98, v110, v110
    v_mul_f32 v99, v111, v111
    v_fmac_f32 v96, v112, v112
    v_fmac_f32 v97, v113, v113
    v_fmac_f32 v98, v114, v114
    v_fmac_f32 v99, v115, v115
    v_fmac_f32 v96, v116, v116
    v_fmac_f32 v97, v117, v117
    v_fmac_f32 v98, v118, v118
    v_fmac_f32 v99, v119, v119
    v_fmac_f32 v96, v120, v120
    v_fmac_f32 v97, v121, v121
    v_fmac_f32 v98, v122, v122
    v_fmac_f32 v99, v123, v123
    v_add_f32 v96, v96, v98
    v_add_f32 v97, v97, v99
    v_add_f32 v96, v96, v97
    v_sub_f32 v80, v80, v105
    v_sub_f32 v81, v81, v105
    v_sub_f32 v82, v82, v105
    v_sub_f32 v83, v83, v105
    v_sub_f32 v84, v84, v105
    v_sub_f32 v85, v85, v105
    v_sub_f32 v86, v86, v105
    v_sub_f32 v87, v87, v105
    v_sub_f32 v88, v88, v105
    v_sub_f32 v89, v89, v105
    v_sub_f32 v90, v90, v105
    v_sub_f32 v91, v91, v105
    v_sub_f32 v92, v92, v105
    v_sub_f32 v93, v93, v105
    v_sub_f32 v94, v94, v105
    v_sub_f32 v95, v95, v105
    v_add_f32_dpp v96, v96, v96 quad_perm:[1,0,3,2] row_mask:0xf bank_mask:0xf
    s_nop 1
    v_add_f32_dpp v96, v96, v96 quad_perm:[2,3,0,1] row_mask:0xf bank_mask:0xf
    s_nop 1
    v_add_f32_dpp v96, v96, v96 row_half_mirror row_mask:0xf bank_mask:0xf
    s_nop 1
    v_add_f32_dpp v96, v96, v96 row_mirror row_mask:0xf bank_mask:0xf
    v_mov_b32 v97, v96
    s_nop 1
    v_permlane16_swap_b32 v96, v97
    v_add_f32 v96, v96, v97
    v_cvt_pk_bf16_f32 v108, v80, v81
    v_cvt_pk_bf16_f32 v109, v82, v83
    v_cvt_pk_bf16_f32 v110, v84, v85
    v_cvt_pk_bf16_f32 v111, v86, v87
    v_cvt_pk_bf16_f32 v112, v88, v89
    v_cvt_pk_bf16_f32 v113, v90, v91
    v_cvt_pk_bf16_f32 v114, v92, v93
    v_cvt_pk_bf16_f32 v115, v94, v95
    v_mul_f32 v96, 0x3b000000, v96
    v_cvt_pk_bf16_f32 v96, v96, v96
    v_lshlrev_b32 v96, 16, v96
    v_add_f32 v96, 0x3727c5ac, v96
    v_cvt_pk_bf16_f32 v96, v96, v96
    v_lshlrev_b32 v96, 16, v96
    v_sqrt_f32 v96, v96
    v_lshlrev_b32 v80, 16, v108
    v_and_b32 v81, 0xffff0000, v108
    v_lshlrev_b32 v82, 16, v109
    v_and_b32 v83, 0xffff0000, v109
    v_lshlrev_b32 v84, 16, v110
    v_and_b32 v85, 0xffff0000, v110
    v_lshlrev_b32 v86, 16, v111
    v_and_b32 v87, 0xffff0000, v111
    v_lshlrev_b32 v88, 16, v112
    v_and_b32 v89, 0xffff0000, v112
    v_lshlrev_b32 v90, 16, v113
    v_and_b32 v91, 0xffff0000, v113
    v_lshlrev_b32 v92, 16, v114
    v_and_b32 v93, 0xffff0000, v114
    v_lshlrev_b32 v94, 16, v115
    v_and_b32 v95, 0xffff0000, v115
    v_cvt_pk_bf16_f32 v106, v96, v96
    v_lshlrev_b32 v106, 16, v106
    v_rcp_f32 v107, v106
    s_nop 0
    v_mul_f32 v108, v80, v107
    v_mul_f32 v109, v81, v107
    v_mul_f32 v110, v82, v107
    v_mul_f32 v111, v83, v107
    v_mul_f32 v112, v84, v107
    v_mul_f32 v113, v85, v107
    v_mul_f32 v114, v86, v107
    v_mul_f32 v115, v87, v107
    v_mul_f32 v116, v88, v107
    v_mul_f32 v117, v89, v107
    v_mul_f32 v118, v90, v107
    v_mul_f32 v119, v91, v107
    v_mul_f32 v120, v92, v107
    v_mul_f32 v121, v93, v107
    v_mul_f32 v122, v94, v107
    v_mul_f32 v123, v95, v107
    v_fma_f32 v80, -v108, v106, v80
    v_fma_f32 v81, -v109, v106, v81
    v_fma_f32 v82, -v110, v106, v82
    v_fma_f32 v83, -v111, v106, v83
    v_fma_f32 v84, -v112, v106, v84
    v_fma_f32 v85, -v113, v106, v85
    v_fma_f32 v86, -v114, v106, v86
    v_fma_f32 v87, -v115, v106, v87
    v_fma_f32 v88, -v116, v106, v88
    v_fma_f32 v89, -v117, v106, v89
    v_fma_f32 v90, -v118, v106, v90
    v_fma_f32 v91, -v119, v106, v91
    v_fma_f32 v92, -v120, v106, v92
    v_fma_f32 v93, -v121, v106, v93
    v_fma_f32 v94, -v122, v106, v94
    v_fma_f32 v95, -v123, v106, v95
    v_fma_f32 v108, v80, v107, v108
    v_fma_f32 v109, v81, v107, v109
    v_fma_f32 v110, v82, v107, v110
    v_fma_f32 v111, v83, v107, v111
    v_fma_f32 v112, v84, v107, v112
    v_fma_f32 v113, v85, v107, v113
    v_fma_f32 v114, v86, v107, v114
    v_fma_f32 v115, v87, v107, v115
    v_fma_f32 v116, v88, v107, v116
    v_fma_f32 v117, v89, v107, v117
    v_fma_f32 v118, v90, v107, v118
    v_fma_f32 v119, v91, v107, v119
    v_fma_f32 v120, v92, v107, v120
    v_fma_f32 v121, v93, v107, v121
    v_fma_f32 v122, v94, v107, v122
    v_fma_f32 v123, v95, v107, v123
    v_cvt_pk_bf16_f32 v80, v108, v109
    v_cvt_pk_bf16_f32 v81, v110, v111
    v_cvt_pk_bf16_f32 v82, v112, v113
    v_cvt_pk_bf16_f32 v83, v114, v115
    v_cvt_pk_bf16_f32 v84, v116, v117
    v_cvt_pk_bf16_f32 v85, v118, v119
    v_cvt_pk_bf16_f32 v86, v120, v121
    v_cvt_pk_bf16_f32 v87, v122, v123
    v_add_u32 v72, 131072, v72
    ds_write_b128 v72, v[80:83]
    ds_write_b128 v72, v[84:87] offset:16
    s_mov_b64 exec, 1
    ds_write_b32 v4, v6 offset:0
    s_mov_b64 exec, -1
    s_waitcnt lgkmcnt(0)
    s_add_u32 s31, s31, 1
    s_and_b32 s72, s31, 0x3ff
    v_mov_b32 v5, s72
    v_mov_b32 v59, s31
    s_lshl_b32 s76, s31, 4
    s_or_b32 s79, s79, s76
    v_mov_b32 v54, s79
    s_lshl_b32 s76, s29, 2
    s_add_u32 s75, s62, s76
    v_mov_b32 v2, 0
    s_mov_b64 exec, 1
    buffer_store_dword v54, v2, s[68:71], s75 offen
    s_mov_b64 exec, -1
    v_and_b32 v75, 15, v1
    v_lshlrev_b32 v75, 13, v75
    v_lshrrev_b32 v8, 4, v1
    v_lshl_add_u32 v75, v8, 5, v75
    s_lshl_b32 s77, s28, 14
    s_and_b32 s78, s29, 1
    s_lshl_b32 s78, s78, 12
    s_add_u32 s77, s77, s78
    s_lshr_b32 s78, s29, 1
    s_add_u32 s78, s78, s3
    s_and_b32 s78, s78, 15
    s_lshl_b32 s78, s78, 8
    s_add_u32 s77, s77, s78
    s_add_u32 s61, s77, 0x80000
    s_add_u32 s60, s77, 0x10000
    v_and_b32 v2, 1, v1
    v_lshlrev_b32 v2, 10, v2
    v_lshrrev_b32 v3, 4, v1
    v_lshl_add_u32 v2, v3, 3, v2
    s_and_b32 s75, s29, 1
    s_lshl_b32 s75, s75, 9
    s_add_u32 s75, s75, 131072
    v_add_u32 v2, s75, v2
    ds_read2_b64 v[128:131], v2 offset0:0 offset1:4
    ds_read2_b64 v[132:135], v2 offset0:8 offset1:12
    ds_read2_b64 v[136:139], v2 offset0:16 offset1:20
    ds_read2_b64 v[140:143], v2 offset0:24 offset1:28
    ds_read2_b64 v[144:147], v2 offset0:32 offset1:36
    ds_read2_b64 v[148:151], v2 offset0:40 offset1:44
    ds_read2_b64 v[152:155], v2 offset0:48 offset1:52
    ds_read2_b64 v[156:159], v2 offset0:56 offset1:60
    v_lshrrev_b32 v2, 2, v1
    v_and_b32 v2, 15, v2
    v_lshlrev_b32 v2, 6, v2
    v_bfe_u32 v3, v1, 4, 1
    v_lshl_add_u32 v2, v3, 5, v2
    v_and_b32 v3, 3, v1
    v_lshl_add_u32 v2, v3, 3, v2
    v_add_u32 v73, 98304, v2
    v_xor_b32 v74, 32, v73
    v_mov_b32 v33, v59
    v_mov_b32 v35, v59
    v_mov_b32 v37, v59
    v_mov_b32 v39, v59
    v_mov_b32 v41, v59
    v_mov_b32 v43, v59
    v_mov_b32 v45, v59
    v_mov_b32 v47, v59
    s_waitcnt vmcnt(4)
    ds_read_b64_tr_b16 v[160:161], v73 offset:0
    ds_read_b64_tr_b16 v[162:163], v73 offset:1024
    ds_read_b64_tr_b16 v[164:165], v74 offset:0
    ds_read_b64_tr_b16 v[166:167], v74 offset:1024
    ds_read_b64_tr_b16 v[168:169], v73 offset:2048
    ds_read_b64_tr_b16 v[170:171], v73 offset:3072
    ds_read_b64_tr_b16 v[172:173], v74 offset:2048
    ds_read_b64_tr_b16 v[174:175], v74 offset:3072
    ds_read_b64_tr_b16 v[176:177], v73 offset:4096
    ds_read_b64_tr_b16 v[178:179], v73 offset:5120
    ds_read_b64_tr_b16 v[180:181], v74 offset:4096
    ds_read_b64_tr_b16 v[182:183], v74 offset:5120
    ds_read_b64_tr_b16 v[184:185], v73 offset:6144
    ds_read_b64_tr_b16 v[186:187], v73 offset:7168
    ds_read_b64_tr_b16 v[188:189], v74 offset:6144
    ds_read_b64_tr_b16 v[190:191], v74 offset:7168
    s_waitcnt lgkmcnt(12)
    v_mfma_f32_16x16x32_bf16 v[16:19], v[160:163], v[128:131], 0
    v_mfma_f32_16x16x32_bf16 v[20:23], v[164:167], v[128:131], 0
    s_waitcnt lgkmcnt(8)
    v_mfma_f32_16x16x32_bf16 v[16:19], v[168:171], v[132:135], v[16:19]
    v_mfma_f32_16x16x32_bf16 v[20:23], v[172:175], v[132:135], v[20:23]
    s_waitcnt lgkmcnt(4)
    v_mfma_f32_16x16x32_bf16 v[16:19], v[176:179], v[136:139], v[16:19]
    v_mfma_f32_16x16x32_bf16 v[20:23], v[180:183], v[136:139], v[20:23]
    s_waitcnt lgkmcnt(0)
    v_mfma_f32_16x16x32_bf16 v[16:19], v[184:187], v[140:143], v[16:19]
    v_mfma_f32_16x16x32_bf16 v[20:23], v[188:191], v[140:143], v[20:23]
    ds_read_b64_tr_b16 v[160:161], v73 offset:8192
    ds_read_b64_tr_b16 v[162:163], v73 offset:9216
    ds_read_b64_tr_b16 v[164:165], v74 offset:8192
    ds_read_b64_tr_b16 v[166:167], v74 offset:9216
    ds_read_b64_tr_b16 v[168:169], v73 offset:10240
    ds_read_b64_tr_b16 v[170:171], v73 offset:11264
    ds_read_b64_tr_b16 v[172:173], v74 offset:10240
    ds_read_b64_tr_b16 v[174:175], v74 offset:11264
    ds_read_b64_tr_b16 v[176:177], v73 offset:12288
    ds_read_b64_tr_b16 v[178:179], v73 offset:13312
    ds_read_b64_tr_b16 v[180:181], v74 offset:12288
    ds_read_b64_tr_b16 v[182:183], v74 offset:13312
    ds_read_b64_tr_b16 v[184:185], v73 offset:14336
    ds_read_b64_tr_b16 v[186:187], v73 offset:15360
    ds_read_b64_tr_b16 v[188:189], v74 offset:14336
    ds_read_b64_tr_b16 v[190:191], v74 offset:15360
    s_waitcnt lgkmcnt(12)
    v_mfma_f32_16x16x32_bf16 v[16:19], v[160:163], v[144:147], v[16:19]
    v_mfma_f32_16x16x32_bf16 v[20:23], v[164:167], v[144:147], v[20:23]
    s_waitcnt lgkmcnt(8)
    v_mfma_f32_16x16x32_bf16 v[16:19], v[168:171], v[148:151], v[16:19]
    v_mfma_f32_16x16x32_bf16 v[20:23], v[172:175], v[148:151], v[20:23]
    s_waitcnt lgkmcnt(4)
    v_mfma_f32_16x16x32_bf16 v[16:19], v[176:179], v[152:155], v[16:19]
    v_mfma_f32_16x16x32_bf16 v[20:23], v[180:183], v[152:155], v[20:23]
    s_waitcnt lgkmcnt(0)
    v_mfma_f32_16x16x32_bf16 v[16:19], v[184:187], v[156:159], v[16:19]
    v_mfma_f32_16x16x32_bf16 v[20:23], v[188:191], v[156:159], v[20:23]
    s_mov_b64 exec, 1
    ds_write_b32 v4, v6 offset:4
    s_mov_b64 exec, -1
    s_nop 3
    v_mov_b32 v32, v16
    v_mov_b32 v34, v17
    v_mov_b32 v36, v18
    v_mov_b32 v38, v19
    v_mov_b32 v40, v20
    v_mov_b32 v42, v21
    v_mov_b32 v44, v22
    v_mov_b32 v46, v23
    s_mov_b32 exec_lo, 0x00030003
    s_mov_b32 exec_hi, 0x00030003
    buffer_store_dwordx4 v[32:35], v75, s[68:71], s60 offen offset:0
    buffer_store_dwordx4 v[36:39], v75, s[68:71], s60 offen offset:16
    buffer_store_dwordx4 v[40:43], v75, s[68:71], s60 offen offset:128
    buffer_store_dwordx4 v[44:47], v75, s[68:71], s60 offen offset:144
    s_mov_b64 exec, -1
    s_mov_b32 s58, 0
    s_mov_b32 s79, 0
    v_and_b32 v76, 31, v1
    v_lshlrev_b32 v76, 2, v76
    s_add_u32 s77, s64, 0x10000
    s_add_u32 s78, s77, 4096
    v_lshlrev_b32 v2, 4, v1
    s_mov_b32 s74, 32768
    buffer_load_dword v160, v76, s[68:71], s62 offen sc1
    buffer_load_dwordx4 v[128:131], v2, s[68:71], s77 offen offset:0 sc1
    buffer_load_dwordx4 v[132:135], v2, s[68:71], s77 offen offset:1024 sc1
    buffer_load_dwordx4 v[136:139], v2, s[68:71], s77 offen offset:2048 sc1
    buffer_load_dwordx4 v[140:143], v2, s[68:71], s77 offen offset:3072 sc1
    buffer_load_dwordx4 v[144:147], v2, s[68:71], s78 offen offset:0 sc1
    buffer_load_dwordx4 v[148:151], v2, s[68:71], s78 offen offset:1024 sc1
    buffer_load_dwordx4 v[152:155], v2, s[68:71], s78 offen offset:2048 sc1
    buffer_load_dwordx4 v[156:159], v2, s[68:71], s78 offen offset:3072 sc1
    s_sleep 12
    buffer_load_dword v196, v76, s[68:71], s62 offen sc1
    buffer_load_dwordx4 v[164:167], v2, s[68:71], s77 offen offset:0 sc1
    buffer_load_dwordx4 v[168:171], v2, s[68:71], s77 offen offset:1024 sc1
    buffer_load_dwordx4 v[172:175], v2, s[68:71], s77 offen offset:2048 sc1
    buffer_load_dwordx4 v[176:179], v2, s[68:71], s77 offen offset:3072 sc1
    buffer_load_dwordx4 v[180:183], v2, s[68:71], s78 offen offset:0 sc1
    buffer_load_dwordx4 v[184:187], v2, s[68:71], s78 offen offset:1024 sc1
    buffer_load_dwordx4 v[188:191], v2, s[68:71], s78 offen offset:2048 sc1
    buffer_load_dwordx4 v[192:195], v2, s[68:71], s78 offen offset:3072 sc1
Lqq_72:
    s_waitcnt vmcnt(9)
    s_cmp_lg_u32 s58, 0
    s_cbranch_scc1 Lk_76
    v_xor_b32 v58, v160, v54
    v_lshrrev_b32 v58, 4, v58
    v_cmp_ne_u32 vcc, 0, v58
    s_cbranch_vccz Lx_78
    s_cmp_gt_u32 s74, 32766
    s_cbranch_scc1 Lk_76
    s_cmp_lg_u32 s79, 0
    s_cbranch_scc1 Lg2_79
    s_mov_b32 s79, 1
    s_lshl_b32 s75, s28, 7
    s_lshl_b32 s76, s29, 2
    s_add_u32 s75, s75, s76
    s_add_u32 s75, s75, 0x2000
    v_mov_b32 v3, 0
    s_mov_b64 exec, 1
    buffer_store_dword v54, v3, s[68:71], s75 offen sc1
    s_mov_b64 exec, -1
Lg2_79:
    s_xor_b32 s62, s62, 0x3000
    s_branch Lk_76
Lx_78:
    v_cmp_ne_u32 vcc, v160, v54
    s_mov_b32 s58, 2
    s_cbranch_vccz Lr_77
    s_mov_b32 s58, 1
Lr_77:
    v_mov_b32 v58, s58
    s_mov_b64 exec, 1
    ds_write_b32 v4, v58 offset:36
    s_mov_b64 exec, -1
    s_lshl_b32 s62, s28, 7
    s_add_u32 s62, s62, 0x1000
    s_cmp_eq_u32 s58, 2
    s_cbranch_scc1 Lk_76
    s_mov_b32 exec_lo, 0x00030003
    s_mov_b32 exec_hi, 0x00030003
    buffer_store_dwordx4 v[32:35], v75, s[68:71], s61 offen offset:0 sc1
    buffer_store_dwordx4 v[36:39], v75, s[68:71], s61 offen offset:16 sc1
    buffer_store_dwordx4 v[40:43], v75, s[68:71], s61 offen offset:128 sc1
    buffer_store_dwordx4 v[44:47], v75, s[68:71], s61 offen offset:144 sc1
    s_mov_b64 exec, -1
Lk_76:
    v_xor_b32 v58, v129, v59
    v_bitop3_b32 v58, v58, v131, v59 bitop3:0xf6
    v_bitop3_b32 v58, v58, v133, v59 bitop3:0xf6
    v_bitop3_b32 v58, v58, v135, v59 bitop3:0xf6
    v_bitop3_b32 v58, v58, v137, v59 bitop3:0xf6
    v_bitop3_b32 v58, v58, v139, v59 bitop3:0xf6
    v_bitop3_b32 v58, v58, v141, v59 bitop3:0xf6
    v_bitop3_b32 v58, v58, v143, v59 bitop3:0xf6
    v_bitop3_b32 v58, v58, v145, v59 bitop3:0xf6
    v_bitop3_b32 v58, v58, v147, v59 bitop3:0xf6
    v_bitop3_b32 v58, v58, v149, v59 bitop3:0xf6
    v_bitop3_b32 v58, v58, v151, v59 bitop3:0xf6
    v_bitop3_b32 v58, v58, v153, v59 bitop3:0xf6
    v_bitop3_b32 v58, v58, v155, v59 bitop3:0xf6
    v_bitop3_b32 v58, v58, v157, v59 bitop3:0xf6
    v_bitop3_b32 v58, v58, v159, v59 bitop3:0xf6
    v_cmp_ne_u32 vcc, 0, v58
    s_cbranch_vccnz Ln_80
    s_cmp_lg_u32 s58, 0
    s_cbranch_scc1 Lqqd_74
Ln_80:
    s_cmp_lg_u32 s58, 1
    s_cbranch_scc1 Lm_81
    s_add_u32 s75, s64, 0x80000
    s_add_u32 s76, s64, 0x10000
    s_xor_b32 s75, s75, s76
    s_xor_b32 s77, s77, s75
    s_add_u32 s78, s77, 4096
Lm_81:
    buffer_load_dword v160, v76, s[68:71], s62 offen sc1
    buffer_load_dwordx4 v[128:131], v2, s[68:71], s77 offen offset:0 sc1
    buffer_load_dwordx4 v[132:135], v2, s[68:71], s77 offen offset:1024 sc1
    buffer_load_dwordx4 v[136:139], v2, s[68:71], s77 offen offset:2048 sc1
    buffer_load_dwordx4 v[140:143], v2, s[68:71], s77 offen offset:3072 sc1
    buffer_load_dwordx4 v[144:147], v2, s[68:71], s78 offen offset:0 sc1
    buffer_load_dwordx4 v[148:151], v2, s[68:71], s78 offen offset:1024 sc1
    buffer_load_dwordx4 v[152:155], v2, s[68:71], s78 offen offset:2048 sc1
    buffer_load_dwordx4 v[156:159], v2, s[68:71], s78 offen offset:3072 sc1
    s_waitcnt vmcnt(9)
    s_cmp_lg_u32 s58, 0
    s_cbranch_scc1 Lk_82
    v_xor_b32 v58, v196, v54
    v_lshrrev_b32 v58, 4, v58
    v_cmp_ne_u32 vcc, 0, v58
    s_cbranch_vccz Lx_84
    s_cmp_gt_u32 s74, 32766
    s_cbranch_scc1 Lk_82
    s_cmp_lg_u32 s79, 0
    s_cbranch_scc1 Lg2_85
    s_mov_b32 s79, 1
    s_lshl_b32 s75, s28, 7
    s_lshl_b32 s76, s29, 2
    s_add_u32 s75, s75, s76
    s_add_u32 s75, s75, 0x2000
    v_mov_b32 v3, 0
    s_mov_b64 exec, 1
    buffer_store_dword v54, v3, s[68:71], s75 offen sc1
    s_mov_b64 exec, -1
Lg2_85:
    s_xor_b32 s62, s62, 0x3000
    s_branch Lk_82
Lx_84:
    v_cmp_ne_u32 vcc, v196, v54
    s_mov_b32 s58, 2
    s_cbranch_vccz Lr_83
    s_mov_b32 s58, 1
Lr_83:
    v_mov_b32 v58, s58
    s_mov_b64 exec, 1
    ds_write_b32 v4, v58 offset:36
    s_mov_b64 exec, -1
    s_lshl_b32 s62, s28, 7
    s_add_u32 s62, s62, 0x1000
    s_cmp_eq_u32 s58, 2
    s_cbranch_scc1 Lk_82
    s_mov_b32 exec_lo, 0x00030003
    s_mov_b32 exec_hi, 0x00030003
    buffer_store_dwordx4 v[32:35], v75, s[68:71], s61 offen offset:0 sc1
    buffer_store_dwordx4 v[36:39], v75, s[68:71], s61 offen offset:16 sc1
    buffer_store_dwordx4 v[40:43], v75, s[68:71], s61 offen offset:128 sc1
    buffer_store_dwordx4 v[44:47], v75, s[68:71], s61 offen offset:144 sc1
    s_mov_b64 exec, -1
Lk_82:
    v_xor_b32 v58, v165, v59
    v_bitop3_b32 v58, v58, v167, v59 bitop3:0xf6
    v_bitop3_b32 v58, v58, v169, v59 bitop3:0xf6
    v_bitop3_b32 v58, v58, v171, v59 bitop3:0xf6
    v_bitop3_b32 v58, v58, v173, v59 bitop3:0xf6
    v_bitop3_b32 v58, v58, v175, v59 bitop3:0xf6
    v_bitop3_b32 v58, v58, v177, v59 bitop3:0xf6
    v_bitop3_b32 v58, v58, v179, v59 bitop3:0xf6
    v_bitop3_b32 v58, v58, v181, v59 bitop3:0xf6
    v_bitop3_b32 v58, v58, v183, v59 bitop3:0xf6
    v_bitop3_b32 v58, v58, v185, v59 bitop3:0xf6
    v_bitop3_b32 v58, v58, v187, v59 bitop3:0xf6
    v_bitop3_b32 v58, v58, v189, v59 bitop3:0xf6
    v_bitop3_b32 v58, v58, v191, v59 bitop3:0xf6
    v_bitop3_b32 v58, v58, v193, v59 bitop3:0xf6
    v_bitop3_b32 v58, v58, v195, v59 bitop3:0xf6
    v_cmp_ne_u32 vcc, 0, v58
    s_cbranch_vccnz Ln_86
    s_cmp_lg_u32 s58, 0
    s_cbranch_scc1 Lqqd_75
Ln_86:
    s_cmp_lg_u32 s58, 1
    s_cbranch_scc1 Lm_87
    s_add_u32 s75, s64, 0x80000
    s_add_u32 s76, s64, 0x10000
    s_xor_b32 s75, s75, s76
    s_xor_b32 s77, s77, s75
    s_add_u32 s78, s77, 4096
Lm_87:
    buffer_load_dword v196, v76, s[68:71], s62 offen sc1
    buffer_load_dwordx4 v[164:167], v2, s[68:71], s77 offen offset:0 sc1
    buffer_load_dwordx4 v[168:171], v2, s[68:71], s77 offen offset:1024 sc1
    buffer_load_dwordx4 v[172:175], v2, s[68:71], s77 offen offset:2048 sc1
    buffer_load_dwordx4 v[176:179], v2, s[68:71], s77 offen offset:3072 sc1
    buffer_load_dwordx4 v[180:183], v2, s[68:71], s78 offen offset:0 sc1
    buffer_load_dwordx4 v[184:187], v2, s[68:71], s78 offen offset:1024 sc1
    buffer_load_dwordx4 v[188:191], v2, s[68:71], s78 offen offset:2048 sc1
    buffer_load_dwordx4 v[192:195], v2, s[68:71], s78 offen offset:3072 sc1
    s_sub_u32 s74, s74, 1
    s_cbranch_scc0 Lqq_72
    s_branch L_end
Lqqd_74:
    v_add_f32 v128, v128, v144
    v_add_f32 v130, v130, v146
    v_add_f32 v132, v132, v148
    v_add_f32 v134, v134, v150
    v_add_f32 v136, v136, v152
    v_add_f32 v138, v138, v154
    v_add_f32 v140, v140, v156
    v_add_f32 v142, v142, v158
    v_cvt_pk_bf16_f32 v8, v128, v130
    v_cvt_pk_bf16_f32 v9, v132, v134
    v_cvt_pk_bf16_f32 v10, v136, v138
    v_cvt_pk_bf16_f32 v11, v140, v142
    s_branch Lqqc_73
Lqqd_75:
    v_add_f32 v164, v164, v180
    v_add_f32 v166, v166, v182
    v_add_f32 v168, v168, v184
    v_add_f32 v170, v170, v186
    v_add_f32 v172, v172, v188
    v_add_f32 v174, v174, v190
    v_add_f32 v176, v176, v192
    v_add_f32 v178, v178, v194
    v_cvt_pk_bf16_f32 v8, v164, v166
    v_cvt_pk_bf16_f32 v9, v168, v170
    v_cvt_pk_bf16_f32 v10, v172, v174
    v_cvt_pk_bf16_f32 v11, v176, v178
Lqqc_73:
    v_lshlrev_b32 v2, 2, v1
    v_add_u32 v2, 135168, v2
    ds_write_b32 v2, v8 offset:0
    ds_write_b32 v2, v9 offset:256
    ds_write_b32 v2, v10 offset:512
    ds_write_b32 v2, v11 offset:768
    s_mov_b64 exec, 1
    ds_write_b32 v4, v6 offset:8
    s_mov_b64 exec, -1
L_afterq:
    s_cmp_lt_u32 s29, s56
    s_cbranch_scc1 Lnoh_88
    v_lshlrev_b32 v2, 4, v1
    s_mov_b32 s74, 32768
    buffer_load_dwordx4 v[8:11], v2, s[68:71], s65 offen sc1
Lq_89:
    s_waitcnt vmcnt(0)
    v_xor_b32 v58, v8, v5
    v_bitop3_b32 v58, v58, v9, v5 bitop3:0xf6
    v_bitop3_b32 v58, v58, v10, v5 bitop3:0xf6
    v_bitop3_b32 v58, v58, v11, v5 bitop3:0xf6
    v_and_b32 v58, v58, v7
    v_cmp_ne_u32 vcc, 0, v58
    s_cbranch_vccz Lqd_91
    buffer_load_dwordx4 v[8:11], v2, s[68:71], s65 offen sc1
    s_sub_u32 s74, s74, 1
    s_cbranch_scc0 Lq_89
    s_branch L_end
Lqd_91:
    v_add_f32_dpp v8, v8, v8 row_ror:8 row_mask:0xf bank_mask:0xf
    v_add_f32_dpp v9, v9, v9 row_ror:8 row_mask:0xf bank_mask:0xf
    v_add_f32_dpp v10, v10, v10 row_ror:8 row_mask:0xf bank_mask:0xf
    v_add_f32_dpp v11, v11, v11 row_ror:8 row_mask:0xf bank_mask:0xf
    v_permlane16_swap_b32 v8, v9
    s_nop 0
    v_permlane16_swap_b32 v10, v11
    v_add_f32 v8, v8, v9
    v_add_f32 v10, v10, v11
    s_nop 1
    v_permlane32_swap_b32 v8, v10
    v_add_f32 v8, v8, v10
    v_mov_b32 v9, v8
    s_nop 1
    v_permlane16_swap_b32 v8, v9
    v_mov_b32 v10, v8
    v_mov_b32 v11, v9
    s_nop 0
    v_permlane32_swap_b32 v8, v10
    v_permlane32_swap_b32 v9, v11
    v_cvt_pk_bf16_f32 v12, v8, v9
    v_cvt_pk_bf16_f32 v13, v10, v11
    v_lshlrev_b32 v8, 16, v12
    v_and_b32 v9, 0xffff0000, v12
    v_lshlrev_b32 v10, 16, v13
    v_and_b32 v11, 0xffff0000, v13
    v_mov_b32_dpp v96, v8 row_ror:12 row_mask:0xf bank_mask:0xf
    v_mov_b32_dpp v97, v9 row_ror:12 row_mask:0xf bank_mask:0xf
    v_mov_b32_dpp v98, v10 row_ror:12 row_mask:0xf bank_mask:0xf
    v_mov_b32_dpp v99, v11 row_ror:12 row_mask:0xf bank_mask:0xf
    s_mov_b32 s78, 0xbfb8aa3b
    v_mul_f32 v8, s78, v8
    v_mul_f32 v9, s78, v9
    v_mul_f32 v10, s78, v10
    v_mul_f32 v11, s78, v11
    v_exp_f32 v8, v8
    v_exp_f32 v9, v9
    v_exp_f32 v10, v10
    v_exp_f32 v11, v11
    v_add_f32 v8, 1.0, v8
    v_add_f32 v9, 1.0, v9
    v_add_f32 v10, 1.0, v10
    v_add_f32 v11, 1.0, v11
    v_rcp_f32 v8, v8
    v_rcp_f32 v9, v9
    v_rcp_f32 v10, v10
    v_rcp_f32 v11, v11
    v_cvt_pk_bf16_f32 v12, v8, v9
    v_cvt_pk_bf16_f32 v13, v10, v11
    v_lshlrev_b32 v8, 16, v12
    v_and_b32 v9, 0xffff0000, v12
    v_lshlrev_b32 v10, 16, v13
    v_and_b32 v11, 0xffff0000, v13
    v_mul_f32 v8, v8, v96
    v_mul_f32 v9, v9, v97
    v_mul_f32 v10, v10, v98
    v_mul_f32 v11, v11, v99
    v_cvt_pk_bf16_f32 v8, v8, v8
    v_cvt_pk_bf16_f32 v9, v9, v9
    v_cvt_pk_bf16_f32 v10, v10, v10
    v_cvt_pk_bf16_f32 v11, v11, v11
    v_lshrrev_b32 v2, 1, v1
    v_lshlrev_b32 v2, 6, v2
    v_and_b32 v3, 1, v1
    v_lshl_add_u32 v2, v3, 2, v2
    v_add_u32 v2, 136448, v2
    s_mov_b64 exec, 0xf
    ds_write_b32 v2, v8 offset:0
    ds_write_b32 v2, v9 offset:16
    ds_write_b32 v2, v10 offset:32
    ds_write_b32 v2, v11 offset:48
    s_mov_b64 exec, 1
    ds_write_b32 v4, v6 offset:24
    s_mov_b64 exec, -1
Lqc_90:
Lnoh_88:
    s_lshl_b32 s79, s28, 2
    s_lshr_b32 s76, s29, 3
    s_add_u32 s79, s79, s76
    s_lshl_b32 s79, s79, 9
    s_add_u32 s79, s79, 0x40000
    v_lshrrev_b32 v77, 5, v1
    v_lshlrev_b32 v77, 8, v77
    v_and_b32 v3, 7, v1
    v_lshl_add_u32 v77, v3, 4, v77
    v_lshrrev_b32 v2, 5, v1
    v_lshlrev_b32 v2, 10, v2
    v_and_b32 v3, 7, v1
    v_lshl_add_u32 v2, v3, 6, v2
    v_bfe_u32 v3, v1, 3, 2
    v_lshl_add_u32 v2, v3, 4, v2
    v_lshrrev_b32 v55, 5, v1
    v_lshlrev_b32 v55, 6, v55
    v_lshl_add_u32 v55, v3, 2, v55
    v_add_u32 v55, 136320, v55
    s_mov_b32 s78, 0x3fb8aa3b
    v_lshlrev_b32 v78, 4, v1
    s_lshl_b32 s60, s29, 10
    s_lshl_b32 s75, s28, 7
    s_add_u32 s61, s60, s75
    s_add_u32 s61, s61, 0x44000
    s_add_u32 s60, s60, 0x44000
    s_mov_b32 s74, 1048576
Lw_92:
    ds_read_b32 v96, v4 offset:16
    s_waitcnt lgkmcnt(0)
    v_readfirstlane_b32 s75, v96
    s_nop 0
    s_cmp_ge_u32 s75, 5
    s_cbranch_scc1 Lwd_93
    s_sleep 1
    s_sub_u32 s74, s74, 1
    s_cbranch_scc0 Lw_92
    s_branch L_end
Lwd_93:
    s_add_u32 s75, s66, 0x0
    s_mov_b64 exec, 0xffff
    buffer_load_dword v251, v79, s[68:71], s75 offen nt
    s_mov_b64 exec, -1
    s_add_u32 s75, s79, 0x0
    s_mov_b64 exec, 0xf
    buffer_load_dword v252, v79, s[68:71], s75 offen nt
    s_mov_b64 exec, -1
    s_add_u32 s75, s67, 0x0
    s_mov_b64 exec, 0xffffffff
    buffer_load_dword v253, v79, s[68:71], s75 offen nt
    s_mov_b64 exec, -1
    s_mov_b64 exec, 0xff
    buffer_load_dword v245, v63, s[40:43], s63 offen
    s_mov_b64 exec, -1
    s_mov_b32 s74, 1048576
Lw_94:
    ds_read_b32 v96, v4 offset:40
    s_waitcnt lgkmcnt(0)
    v_readfirstlane_b32 s75, v96
    s_nop 0
    s_cmp_ge_u32 s75, 4
    s_cbranch_scc1 Lwd_95
    s_sub_u32 s74, s74, 1
    s_cbranch_scc0 Lw_94
    s_branch L_end
Lwd_95:
    s_mov_b32 s74, 32768
    buffer_load_dwordx4 v[8:11], v77, s[68:71], s79 offen sc1
    buffer_load_dwordx4 v[12:15], v77, s[68:71], s79 offen offset:128 sc1
    buffer_load_dwordx4 v[16:19], v2, s[68:71], s66 offen sc1
    buffer_load_dwordx4 v[20:23], v2, s[68:71], s66 offen offset:512 sc1
    s_sleep 3
    buffer_load_dwordx4 v[128:131], v77, s[68:71], s79 offen sc1
    buffer_load_dwordx4 v[132:135], v77, s[68:71], s79 offen offset:128 sc1
    buffer_load_dwordx4 v[136:139], v2, s[68:71], s66 offen sc1
    buffer_load_dwordx4 v[140:143], v2, s[68:71], s66 offen offset:512 sc1
Lq_96:
    s_waitcnt vmcnt(4)
    v_xor_b32 v58, v8, v5
    v_bitop3_b32 v58, v58, v9, v5 bitop3:0xf6
    v_bitop3_b32 v58, v58, v10, v5 bitop3:0xf6
    v_bitop3_b32 v58, v58, v11, v5 bitop3:0xf6
    v_bitop3_b32 v58, v58, v12, v5 bitop3:0xf6
    v_bitop3_b32 v58, v58, v13, v5 bitop3:0xf6
    v_bitop3_b32 v58, v58, v14, v5 bitop3:0xf6
    v_bitop3_b32 v58, v58, v15, v5 bitop3:0xf6
    v_bitop3_b32 v58, v58, v16, v5 bitop3:0xf6
    v_bitop3_b32 v58, v58, v17, v5 bitop3:0xf6
    v_bitop3_b32 v58, v58, v18, v5 bitop3:0xf6
    v_bitop3_b32 v58, v58, v19, v5 bitop3:0xf6
    v_bitop3_b32 v58, v58, v20, v5 bitop3:0xf6
    v_bitop3_b32 v58, v58, v21, v5 bitop3:0xf6
    v_bitop3_b32 v58, v58, v22, v5 bitop3:0xf6
    v_bitop3_b32 v58, v58, v23, v5 bitop3:0xf6
    v_and_b32 v58, v58, v7
    v_cmp_ne_u32 vcc, 0, v58
    s_cbranch_vccz Lqd_98
    buffer_load_dwordx4 v[8:11], v77, s[68:71], s79 offen sc1
    buffer_load_dwordx4 v[12:15], v77, s[68:71], s79 offen offset:128 sc1
    buffer_load_dwordx4 v[16:19], v2, s[68:71], s66 offen sc1
    buffer_load_dwordx4 v[20:23], v2, s[68:71], s66 offen offset:512 sc1
    s_waitcnt vmcnt(4)
    v_xor_b32 v58, v128, v5
    v_bitop3_b32 v58, v58, v129, v5 bitop3:0xf6
    v_bitop3_b32 v58, v58, v130, v5 bitop3:0xf6
    v_bitop3_b32 v58, v58, v131, v5 bitop3:0xf6
    v_bitop3_b32 v58, v58, v132, v5 bitop3:0xf6
    v_bitop3_b32 v58, v58, v133, v5 bitop3:0xf6
    v_bitop3_b32 v58, v58, v134, v5 bitop3:0xf6
    v_bitop3_b32 v58, v58, v135, v5 bitop3:0xf6
    v_bitop3_b32 v58, v58, v136, v5 bitop3:0xf6
    v_bitop3_b32 v58, v58, v137, v5 bitop3:0xf6
    v_bitop3_b32 v58, v58, v138, v5 bitop3:0xf6
    v_bitop3_b32 v58, v58, v139, v5 bitop3:0xf6
    v_bitop3_b32 v58, v58, v140, v5 bitop3:0xf6
    v_bitop3_b32 v58, v58, v141, v5 bitop3:0xf6
    v_bitop3_b32 v58, v58, v142, v5 bitop3:0xf6
    v_bitop3_b32 v58, v58, v143, v5 bitop3:0xf6
    v_and_b32 v58, v58, v7
    v_cmp_ne_u32 vcc, 0, v58
    s_cbranch_vccz Lqd_99
    buffer_load_dwordx4 v[128:131], v77, s[68:71], s79 offen sc1
    buffer_load_dwordx4 v[132:135], v77, s[68:71], s79 offen offset:128 sc1
    buffer_load_dwordx4 v[136:139], v2, s[68:71], s66 offen sc1
    buffer_load_dwordx4 v[140:143], v2, s[68:71], s66 offen offset:512 sc1
    s_sub_u32 s74, s74, 1
    s_cbranch_scc0 Lq_96
    s_branch L_end
Lqd_98:
    v_and_b32 v8, s73, v8
    v_and_b32 v12, s73, v12
    v_max_f32 v96, v8, v12
    v_and_b32 v9, s73, v9
    v_and_b32 v13, s73, v13
    v_max_f32_dpp v96, v96, v96 quad_perm:[1,0,3,2] row_mask:0xf bank_mask:0xf
    s_nop 1
    v_max_f32_dpp v96, v96, v96 quad_perm:[2,3,0,1] row_mask:0xf bank_mask:0xf
    s_nop 1
    v_max_f32_dpp v96, v96, v96 row_half_mirror row_mask:0xf bank_mask:0xf
    v_sub_f32 v8, v8, v96
    v_sub_f32 v12, v12, v96
    v_mul_f32 v8, s78, v8
    v_mul_f32 v12, s78, v12
    v_exp_f32 v8, v8
    v_exp_f32 v12, v12
    s_nop 0
    v_mul_f32 v97, v8, v9
    v_mul_f32 v16, v8, v16
    v_mul_f32 v17, v8, v17
    v_mul_f32 v18, v8, v18
    v_mul_f32 v19, v8, v19
    v_fmac_f32 v97, v12, v13
    v_fmac_f32 v16, v12, v20
    v_fmac_f32 v17, v12, v21
    v_fmac_f32 v18, v12, v22
    v_fmac_f32 v19, v12, v23
    v_add_f32_dpp v97, v97, v97 quad_perm:[1,0,3,2] row_mask:0xf bank_mask:0xf
    v_add_f32_dpp v16, v16, v16 quad_perm:[1,0,3,2] row_mask:0xf bank_mask:0xf
    v_add_f32_dpp v17, v17, v17 quad_perm:[1,0,3,2] row_mask:0xf bank_mask:0xf
    v_add_f32_dpp v18, v18, v18 quad_perm:[1,0,3,2] row_mask:0xf bank_mask:0xf
    v_add_f32_dpp v19, v19, v19 quad_perm:[1,0,3,2] row_mask:0xf bank_mask:0xf
    v_add_f32_dpp v97, v97, v97 quad_perm:[2,3,0,1] row_mask:0xf bank_mask:0xf
    v_add_f32_dpp v16, v16, v16 quad_perm:[2,3,0,1] row_mask:0xf bank_mask:0xf
    v_add_f32_dpp v17, v17, v17 quad_perm:[2,3,0,1] row_mask:0xf bank_mask:0xf
    v_add_f32_dpp v18, v18, v18 quad_perm:[2,3,0,1] row_mask:0xf bank_mask:0xf
    v_add_f32_dpp v19, v19, v19 quad_perm:[2,3,0,1] row_mask:0xf bank_mask:0xf
    v_add_f32_dpp v97, v97, v97 row_half_mirror row_mask:0xf bank_mask:0xf
    v_add_f32_dpp v16, v16, v16 row_half_mirror row_mask:0xf bank_mask:0xf
    v_add_f32_dpp v17, v17, v17 row_half_mirror row_mask:0xf bank_mask:0xf
    v_add_f32_dpp v18, v18, v18 row_half_mirror row_mask:0xf bank_mask:0xf
    v_add_f32_dpp v19, v19, v19 row_half_mirror row_mask:0xf bank_mask:0xf
    v_rcp_f32 v97, v97
    s_nop 0
    v_mul_f32 v16, v97, v16
    v_mul_f32 v17, v97, v17
    v_mul_f32 v18, v97, v18
    v_mul_f32 v19, v97, v19
    v_cvt_pk_bf16_f32 v16, v16, v16
    v_cvt_pk_bf16_f32 v17, v17, v17
    v_cvt_pk_bf16_f32 v18, v18, v18
    v_cvt_pk_bf16_f32 v19, v19, v19
    s_mov_b32 exec_lo, 0x01010101
    s_mov_b32 exec_hi, 0x01010101
    ds_write_b32 v55, v16 offset:0
    ds_write_b32 v55, v17 offset:16
    ds_write_b32 v55, v18 offset:32
    ds_write_b32 v55, v19 offset:48
    s_mov_b64 exec, 1
    ds_write_b32 v4, v6 offset:28
    s_mov_b64 exec, -1
    s_branch Lqc_97
Lqd_99:
    v_and_b32 v128, s73, v128
    v_and_b32 v132, s73, v132
    v_max_f32 v96, v128, v132
    v_and_b32 v129, s73, v129
    v_and_b32 v133, s73, v133
    v_max_f32_dpp v96, v96, v96 quad_perm:[1,0,3,2] row_mask:0xf bank_mask:0xf
    s_nop 1
    v_max_f32_dpp v96, v96, v96 quad_perm:[2,3,0,1] row_mask:0xf bank_mask:0xf
    s_nop 1
    v_max_f32_dpp v96, v96, v96 row_half_mirror row_mask:0xf bank_mask:0xf
    v_sub_f32 v128, v128, v96
    v_sub_f32 v132, v132, v96
    v_mul_f32 v128, s78, v128
    v_mul_f32 v132, s78, v132
    v_exp_f32 v128, v128
    v_exp_f32 v132, v132
    s_nop 0
    v_mul_f32 v97, v128, v129
    v_mul_f32 v136, v128, v136
    v_mul_f32 v137, v128, v137
    v_mul_f32 v138, v128, v138
    v_mul_f32 v139, v128, v139
    v_fmac_f32 v97, v132, v133
    v_fmac_f32 v136, v132, v140
    v_fmac_f32 v137, v132, v141
    v_fmac_f32 v138, v132, v142
    v_fmac_f32 v139, v132, v143
    v_add_f32_dpp v97, v97, v97 quad_perm:[1,0,3,2] row_mask:0xf bank_mask:0xf
    v_add_f32_dpp v136, v136, v136 quad_perm:[1,0,3,2] row_mask:0xf bank_mask:0xf
    v_add_f32_dpp v137, v137, v137 quad_perm:[1,0,3,2] row_mask:0xf bank_mask:0xf
    v_add_f32_dpp v138, v138, v138 quad_perm:[1,0,3,2] row_mask:0xf bank_mask:0xf
    v_add_f32_dpp v139, v139, v139 quad_perm:[1,0,3,2] row_mask:0xf bank_mask:0xf
    v_add_f32_dpp v97, v97, v97 quad_perm:[2,3,0,1] row_mask:0xf bank_mask:0xf
    v_add_f32_dpp v136, v136, v136 quad_perm:[2,3,0,1] row_mask:0xf bank_mask:0xf
    v_add_f32_dpp v137, v137, v137 quad_perm:[2,3,0,1] row_mask:0xf bank_mask:0xf
    v_add_f32_dpp v138, v138, v138 quad_perm:[2,3,0,1] row_mask:0xf bank_mask:0xf
    v_add_f32_dpp v139, v139, v139 quad_perm:[2,3,0,1] row_mask:0xf bank_mask:0xf
    v_add_f32_dpp v97, v97, v97 row_half_mirror row_mask:0xf bank_mask:0xf
    v_add_f32_dpp v136, v136, v136 row_half_mirror row_mask:0xf bank_mask:0xf
    v_add_f32_dpp v137, v137, v137 row_half_mirror row_mask:0xf bank_mask:0xf
    v_add_f32_dpp v138, v138, v138 row_half_mirror row_mask:0xf bank_mask:0xf
    v_add_f32_dpp v139, v139, v139 row_half_mirror row_mask:0xf bank_mask:0xf
    v_rcp_f32 v97, v97
    s_nop 0
    v_mul_f32 v136, v97, v136
    v_mul_f32 v137, v97, v137
    v_mul_f32 v138, v97, v138
    v_mul_f32 v139, v97, v139
    v_cvt_pk_bf16_f32 v136, v136, v136
    v_cvt_pk_bf16_f32 v137, v137, v137
    v_cvt_pk_bf16_f32 v138, v138, v138
    v_cvt_pk_bf16_f32 v139, v139, v139
    s_mov_b32 exec_lo, 0x01010101
    s_mov_b32 exec_hi, 0x01010101
    ds_write_b32 v55, v136 offset:0
    ds_write_b32 v55, v137 offset:16
    ds_write_b32 v55, v138 offset:32
    ds_write_b32 v55, v139 offset:48
    s_mov_b64 exec, 1
    ds_write_b32 v4, v6 offset:28
    s_mov_b64 exec, -1
Lqc_97:
    s_mov_b32 s74, 32768
    buffer_load_dwordx4 v[32:35], v78, s[68:71], s67 offen offset:0 sc1
    buffer_load_dwordx4 v[36:39], v78, s[68:71], s67 offen offset:1024 sc1
    buffer_load_dwordx4 v[40:43], v78, s[68:71], s67 offen offset:2048 sc1
    buffer_load_dwordx4 v[44:47], v78, s[68:71], s67 offen offset:3072 sc1
    s_sleep 3
    buffer_load_dwordx4 v[112:115], v78, s[68:71], s67 offen offset:0 sc1
    buffer_load_dwordx4 v[116:119], v78, s[68:71], s67 offen offset:1024 sc1
    buffer_load_dwordx4 v[120:123], v78, s[68:71], s67 offen offset:2048 sc1
    buffer_load_dwordx4 v[124:127], v78, s[68:71], s67 offen offset:3072 sc1
Lq_100:
    s_waitcnt vmcnt(4)
    v_xor_b32 v58, v32, v5
    v_bitop3_b32 v58, v58, v33, v5 bitop3:0xf6
    v_bitop3_b32 v58, v58, v34, v5 bitop3:0xf6
    v_bitop3_b32 v58, v58, v35, v5 bitop3:0xf6
    v_bitop3_b32 v58, v58, v36, v5 bitop3:0xf6
    v_bitop3_b32 v58, v58, v37, v5 bitop3:0xf6
    v_bitop3_b32 v58, v58, v38, v5 bitop3:0xf6
    v_bitop3_b32 v58, v58, v39, v5 bitop3:0xf6
    v_bitop3_b32 v58, v58, v40, v5 bitop3:0xf6
    v_bitop3_b32 v58, v58, v41, v5 bitop3:0xf6
    v_bitop3_b32 v58, v58, v42, v5 bitop3:0xf6
    v_bitop3_b32 v58, v58, v43, v5 bitop3:0xf6
    v_bitop3_b32 v58, v58, v44, v5 bitop3:0xf6
    v_bitop3_b32 v58, v58, v45, v5 bitop3:0xf6
    v_bitop3_b32 v58, v58, v46, v5 bitop3:0xf6
    v_bitop3_b32 v58, v58, v47, v5 bitop3:0xf6
    v_and_b32 v58, v58, v7
    v_cmp_ne_u32 vcc, 0, v58
    s_cbranch_vccz Lqd_102
    buffer_load_dwordx4 v[32:35], v78, s[68:71], s67 offen offset:0 sc1
    buffer_load_dwordx4 v[36:39], v78, s[68:71], s67 offen offset:1024 sc1
    buffer_load_dwordx4 v[40:43], v78, s[68:71], s67 offen offset:2048 sc1
    buffer_load_dwordx4 v[44:47], v78, s[68:71], s67 offen offset:3072 sc1
    s_waitcnt vmcnt(4)
    v_xor_b32 v58, v112, v5
    v_bitop3_b32 v58, v58, v113, v5 bitop3:0xf6
    v_bitop3_b32 v58, v58, v114, v5 bitop3:0xf6
    v_bitop3_b32 v58, v58, v115, v5 bitop3:0xf6
    v_bitop3_b32 v58, v58, v116, v5 bitop3:0xf6
    v_bitop3_b32 v58, v58, v117, v5 bitop3:0xf6
    v_bitop3_b32 v58, v58, v118, v5 bitop3:0xf6
    v_bitop3_b32 v58, v58, v119, v5 bitop3:0xf6
    v_bitop3_b32 v58, v58, v120, v5 bitop3:0xf6
    v_bitop3_b32 v58, v58, v121, v5 bitop3:0xf6
    v_bitop3_b32 v58, v58, v122, v5 bitop3:0xf6
    v_bitop3_b32 v58, v58, v123, v5 bitop3:0xf6
    v_bitop3_b32 v58, v58, v124, v5 bitop3:0xf6
    v_bitop3_b32 v58, v58, v125, v5 bitop3:0xf6
    v_bitop3_b32 v58, v58, v126, v5 bitop3:0xf6
    v_bitop3_b32 v58, v58, v127, v5 bitop3:0xf6
    v_and_b32 v58, v58, v7
    v_cmp_ne_u32 vcc, 0, v58
    s_cbranch_vccz Lqd_103
    buffer_load_dwordx4 v[112:115], v78, s[68:71], s67 offen offset:0 sc1
    buffer_load_dwordx4 v[116:119], v78, s[68:71], s67 offen offset:1024 sc1
    buffer_load_dwordx4 v[120:123], v78, s[68:71], s67 offen offset:2048 sc1
    buffer_load_dwordx4 v[124:127], v78, s[68:71], s67 offen offset:3072 sc1
    s_sub_u32 s74, s74, 1
    s_cbranch_scc0 Lq_100
    s_branch L_end
Lqd_102:
    v_add_f32 v32, v32, v36
    v_add_f32 v40, v40, v44
    v_add_f32 v33, v33, v37
    v_add_f32 v41, v41, v45
    v_add_f32 v34, v34, v38
    v_add_f32 v42, v42, v46
    v_add_f32 v35, v35, v39
    v_add_f32 v43, v43, v47
    v_add_f32 v32, v32, v40
    v_add_f32 v33, v33, v41
    v_add_f32 v34, v34, v42
    v_add_f32 v35, v35, v43
    v_add_f32_dpp v32, v32, v32 row_ror:8 row_mask:0xf bank_mask:0xf
    v_add_f32_dpp v33, v33, v33 row_ror:8 row_mask:0xf bank_mask:0xf
    v_add_f32_dpp v34, v34, v34 row_ror:8 row_mask:0xf bank_mask:0xf
    v_add_f32_dpp v35, v35, v35 row_ror:8 row_mask:0xf bank_mask:0xf
    v_permlane16_swap_b32 v32, v33
    s_nop 0
    v_permlane16_swap_b32 v34, v35
    v_add_f32 v32, v32, v33
    v_add_f32 v34, v34, v35
    s_nop 1
    v_permlane32_swap_b32 v32, v34
    v_add_f32 v32, v32, v34
    v_mov_b32 v33, v32
    s_nop 1
    v_permlane16_swap_b32 v32, v33
    v_mov_b32 v34, v32
    v_mov_b32 v35, v33
    s_nop 0
    v_permlane32_swap_b32 v32, v34
    v_permlane32_swap_b32 v33, v35
    v_and_or_b32 v32, v32, s73, v5
    v_and_or_b32 v33, v33, s73, v5
    v_and_or_b32 v34, v34, s73, v5
    v_and_or_b32 v35, v35, s73, v5
    s_mov_b64 exec, 0xff
    buffer_store_dwordx4 v[32:35], v78, s[68:71], s61 offen sc1
    s_mov_b64 exec, -1
    s_branch Lqc_101
Lqd_103:
    v_add_f32 v112, v112, v116
    v_add_f32 v120, v120, v124
    v_add_f32 v113, v113, v117
    v_add_f32 v121, v121, v125
    v_add_f32 v114, v114, v118
    v_add_f32 v122, v122, v126
    v_add_f32 v115, v115, v119
    v_add_f32 v123, v123, v127
    v_add_f32 v112, v112, v120
    v_add_f32 v113, v113, v121
    v_add_f32 v114, v114, v122
    v_add_f32 v115, v115, v123
    v_add_f32_dpp v112, v112, v112 row_ror:8 row_mask:0xf bank_mask:0xf
    v_add_f32_dpp v113, v113, v113 row_ror:8 row_mask:0xf bank_mask:0xf
    v_add_f32_dpp v114, v114, v114 row_ror:8 row_mask:0xf bank_mask:0xf
    v_add_f32_dpp v115, v115, v115 row_ror:8 row_mask:0xf bank_mask:0xf
    v_permlane16_swap_b32 v112, v113
    s_nop 0
    v_permlane16_swap_b32 v114, v115
    v_add_f32 v112, v112, v113
    v_add_f32 v114, v114, v115
    s_nop 1
    v_permlane32_swap_b32 v112, v114
    v_add_f32 v112, v112, v114
    v_mov_b32 v113, v112
    s_nop 1
    v_permlane16_swap_b32 v112, v113
    v_mov_b32 v114, v112
    v_mov_b32 v115, v113
    s_nop 0
    v_permlane32_swap_b32 v112, v114
    v_permlane32_swap_b32 v113, v115
    v_and_or_b32 v112, v112, s73, v5
    v_and_or_b32 v113, v113, s73, v5
    v_and_or_b32 v114, v114, s73, v5
    v_and_or_b32 v115, v115, s73, v5
    s_mov_b64 exec, 0xff
    buffer_store_dwordx4 v[112:115], v78, s[68:71], s61 offen sc1
    s_mov_b64 exec, -1
Lqc_101:
    s_and_b32 s75, s29, 7
    s_cmp_lg_u32 s75, s28
    s_cbranch_scc1 Lfin_104
    s_mov_b32 s74, 32768
    buffer_load_dwordx4 v[144:147], v78, s[68:71], s60 offen sc1
    s_sleep 5
    buffer_load_dwordx4 v[148:151], v78, s[68:71], s60 offen sc1
    s_sleep 5
    buffer_load_dwordx4 v[152:155], v78, s[68:71], s60 offen sc1
Lq_105:
    s_waitcnt vmcnt(2)
    v_xor_b32 v58, v144, v5
    v_bitop3_b32 v58, v58, v145, v5 bitop3:0xf6
    v_bitop3_b32 v58, v58, v146, v5 bitop3:0xf6
    v_bitop3_b32 v58, v58, v147, v5 bitop3:0xf6
    v_and_b32 v58, v58, v7
    v_cmp_ne_u32 vcc, 0, v58
    s_cbranch_vccz Lqd_107
    buffer_load_dwordx4 v[144:147], v78, s[68:71], s60 offen sc1
    s_waitcnt vmcnt(2)
    v_xor_b32 v58, v148, v5
    v_bitop3_b32 v58, v58, v149, v5 bitop3:0xf6
    v_bitop3_b32 v58, v58, v150, v5 bitop3:0xf6
    v_bitop3_b32 v58, v58, v151, v5 bitop3:0xf6
    v_and_b32 v58, v58, v7
    v_cmp_ne_u32 vcc, 0, v58
    s_cbranch_vccz Lqd_108
    buffer_load_dwordx4 v[148:151], v78, s[68:71], s60 offen sc1
    s_waitcnt vmcnt(2)
    v_xor_b32 v58, v152, v5
    v_bitop3_b32 v58, v58, v153, v5 bitop3:0xf6
    v_bitop3_b32 v58, v58, v154, v5 bitop3:0xf6
    v_bitop3_b32 v58, v58, v155, v5 bitop3:0xf6
    v_and_b32 v58, v58, v7
    v_cmp_ne_u32 vcc, 0, v58
    s_cbranch_vccz Lqd_109
    buffer_load_dwordx4 v[152:155], v78, s[68:71], s60 offen sc1
    s_sub_u32 s74, s74, 1
    s_cbranch_scc0 Lq_105
    s_branch L_end
Lqd_107:
    v_add_f32_dpp v144, v144, v144 row_ror:8 row_mask:0xf bank_mask:0xf
    v_add_f32_dpp v145, v145, v145 row_ror:8 row_mask:0xf bank_mask:0xf
    v_add_f32_dpp v146, v146, v146 row_ror:8 row_mask:0xf bank_mask:0xf
    v_add_f32_dpp v147, v147, v147 row_ror:8 row_mask:0xf bank_mask:0xf
    v_permlane16_swap_b32 v144, v145
    s_nop 0
    v_permlane16_swap_b32 v146, v147
    v_add_f32 v144, v144, v145
    v_add_f32 v146, v146, v147
    s_nop 1
    v_permlane32_swap_b32 v144, v146
    v_add_f32 v144, v144, v146
    v_mov_b32 v145, v144
    s_nop 1
    v_permlane16_swap_b32 v144, v145
    v_mov_b32 v146, v144
    v_mov_b32 v147, v145
    s_nop 0
    v_permlane32_swap_b32 v144, v146
    v_permlane32_swap_b32 v145, v147
    v_lshlrev_b32 v96, 16, v56
    v_and_b32 v97, 0xffff0000, v56
    v_lshlrev_b32 v98, 16, v57
    v_and_b32 v99, 0xffff0000, v57
    v_add_f32 v144, v144, v96
    v_add_f32 v145, v145, v97
    v_add_f32 v146, v146, v98
    v_add_f32 v147, v147, v99
    v_cvt_pk_bf16_f32 v96, v144, v145
    v_cvt_pk_bf16_f32 v97, v146, v147
    s_mov_b64 exec, 0xff
    buffer_store_dwordx2 v[96:97], v63, s[40:43], s63 offen
    s_branch Lqc_106
Lqd_108:
    v_add_f32_dpp v148, v148, v148 row_ror:8 row_mask:0xf bank_mask:0xf
    v_add_f32_dpp v149, v149, v149 row_ror:8 row_mask:0xf bank_mask:0xf
    v_add_f32_dpp v150, v150, v150 row_ror:8 row_mask:0xf bank_mask:0xf
    v_add_f32_dpp v151, v151, v151 row_ror:8 row_mask:0xf bank_mask:0xf
    v_permlane16_swap_b32 v148, v149
    s_nop 0
    v_permlane16_swap_b32 v150, v151
    v_add_f32 v148, v148, v149
    v_add_f32 v150, v150, v151
    s_nop 1
    v_permlane32_swap_b32 v148, v150
    v_add_f32 v148, v148, v150
    v_mov_b32 v149, v148
    s_nop 1
    v_permlane16_swap_b32 v148, v149
    v_mov_b32 v150, v148
    v_mov_b32 v151, v149
    s_nop 0
    v_permlane32_swap_b32 v148, v150
    v_permlane32_swap_b32 v149, v151
    v_lshlrev_b32 v96, 16, v56
    v_and_b32 v97, 0xffff0000, v56
    v_lshlrev_b32 v98, 16, v57
    v_and_b32 v99, 0xffff0000, v57
    v_add_f32 v148, v148, v96
    v_add_f32 v149, v149, v97
    v_add_f32 v150, v150, v98
    v_add_f32 v151, v151, v99
    v_cvt_pk_bf16_f32 v96, v148, v149
    v_cvt_pk_bf16_f32 v97, v150, v151
    s_mov_b64 exec, 0xff
    buffer_store_dwordx2 v[96:97], v63, s[40:43], s63 offen
    s_branch Lqc_106
Lqd_109:
    v_add_f32_dpp v152, v152, v152 row_ror:8 row_mask:0xf bank_mask:0xf
    v_add_f32_dpp v153, v153, v153 row_ror:8 row_mask:0xf bank_mask:0xf
    v_add_f32_dpp v154, v154, v154 row_ror:8 row_mask:0xf bank_mask:0xf
    v_add_f32_dpp v155, v155, v155 row_ror:8 row_mask:0xf bank_mask:0xf
    v_permlane16_swap_b32 v152, v153
    s_nop 0
    v_permlane16_swap_b32 v154, v155
    v_add_f32 v152, v152, v153
    v_add_f32 v154, v154, v155
    s_nop 1
    v_permlane32_swap_b32 v152, v154
    v_add_f32 v152, v152, v154
    v_mov_b32 v153, v152
    s_nop 1
    v_permlane16_swap_b32 v152, v153
    v_mov_b32 v154, v152
    v_mov_b32 v155, v153
    s_nop 0
    v_permlane32_swap_b32 v152, v154
    v_permlane32_swap_b32 v153, v155
    v_lshlrev_b32 v96, 16, v56
    v_and_b32 v97, 0xffff0000, v56
    v_lshlrev_b32 v98, 16, v57
    v_and_b32 v99, 0xffff0000, v57
    v_add_f32 v152, v152, v96
    v_add_f32 v153, v153, v97
    v_add_f32 v154, v154, v98
    v_add_f32 v155, v155, v99
    v_cvt_pk_bf16_f32 v96, v152, v153
    v_cvt_pk_bf16_f32 v97, v154, v155
    s_mov_b64 exec, 0xff
    buffer_store_dwordx2 v[96:97], v63, s[40:43], s63 offen
Lqc_106:
    s_cmp_lg_u32 s2, 0
    s_cbranch_scc1 Lne_110
    s_mov_b64 exec, 1
    v_mov_b32 v3, s31
    v_mov_b32 v2, 0
    s_mov_b32 s75, 0x0
    buffer_store_dword v3, v2, s[68:71], s75 offen
Lne_110:
Lfin_104:
    s_endpgm
L_compute:
    s_lshl_b32 s78, s30, 14
    v_mov_b32 v18, 136576
    v_mov_b32 v19, 1
    s_barrier
    s_waitcnt lgkmcnt(0)
    s_load_dword s31, s[26:27], 0
    s_mov_b32 s68, s26
    s_mov_b32 s69, s27
    s_mov_b32 s70, 0x20000000
    s_mov_b32 s71, 0x20000
    v_and_b32 v2, 15, v1
    v_lshrrev_b32 v3, 4, v1
    v_xor_b32 v3, v3, v2
    v_lshlrev_b32 v3, 4, v3
    v_lshl_add_u32 v3, v2, 8, v3
    v_add_u32 v244, s78, v3
    v_xor_b32 v245, 64, v244
    v_xor_b32 v246, 128, v244
    v_xor_b32 v247, 192, v244
    v_and_b32 v2, 3, v1
    v_lshlrev_b32 v2, 8, v2
    v_lshrrev_b32 v3, 4, v1
    v_lshl_add_u32 v21, v3, 4, v2
    v_add_u32 v21, 135168, v21
    v_and_b32 v2, 3, v1
    v_lshl_add_u32 v2, v3, 2, v2
    v_lshlrev_b32 v23, 4, v2
    v_add_u32 v23, 133120, v23
    s_lshl_b32 s75, s30, 9
    v_add_u32 v22, s75, v23
    v_bfe_u32 v2, v1, 3, 1
    v_lshl_add_u32 v22, v2, 8, v22
    v_bfe_u32 v2, v1, 2, 1
    v_lshl_add_u32 v22, v2, 3, v22
    v_and_b32 v2, 1, v1
    v_cmp_eq_u32 vcc, 1, v2
    v_mov_b32 v3, 0x0000ffff
    v_mov_b32 v24, 0xffff0000
    v_cndmask_b32 v3, v3, v24, vcc
    v_bfe_u32 v2, v1, 1, 2
    v_cmp_eq_u32 vcc, 0, v2
    s_nop 1
    v_cndmask_b32 v224, 0, v3, vcc
    v_cmp_eq_u32 vcc, 1, v2
    s_nop 1
    v_cndmask_b32 v225, 0, v3, vcc
    v_cmp_eq_u32 vcc, 2, v2
    s_nop 1
    v_cndmask_b32 v226, 0, v3, vcc
    v_cmp_eq_u32 vcc, 3, v2
    s_nop 1
    v_cndmask_b32 v227, 0, v3, vcc
    v_and_b32 v40, 15, v1
    v_lshlrev_b32 v40, 14, v40
    v_lshrrev_b32 v41, 4, v1
    v_lshl_add_u32 v4, v41, 4, v40
    v_lshrrev_b32 v40, 4, v1
    v_lshlrev_b32 v40, 10, v40
    v_and_b32 v41, 15, v1
    v_lshl_add_u32 v5, v41, 4, v40
    s_lshl_b32 s75, s30, 8
    v_add_u32 v5, s75, v5
    v_bfe_u32 v40, v1, 3, 1
    v_lshlrev_b32 v40, 6, v40
    v_lshrrev_b32 v41, 4, v1
    v_lshl_add_u32 v6, v41, 4, v40
    v_add_u32 v6, 136320, v6
    v_lshrrev_b32 v40, 3, v1
    v_lshlrev_b32 v40, 12, v40
    v_and_b32 v41, 7, v1
    v_lshl_add_u32 v7, v41, 4, v40
    s_lshl_b32 s61, s28, 17
    s_lshl_b32 s76, s30, 15
    s_add_u32 s61, s61, s76
    s_lshl_b32 s76, s29, 7
    s_add_u32 s61, s61, s76
    s_add_u32 s61, s61, 0x200000
    s_lshl_b32 s60, s28, 16
    s_lshl_b32 s76, s30, 12
    s_add_u32 s60, s60, s76
    s_lshl_b32 s76, s29, 6
    s_add_u32 s60, s60, s76
    s_add_u32 s60, s60, 0x100000
    v_and_b32 v2, 15, v1
    v_lshlrev_b32 v2, 5, v2
    v_bfe_u32 v3, v1, 4, 1
    v_lshl_add_u32 v2, v3, 4, v2
    v_lshrrev_b32 v3, 5, v1
    v_lshl_add_u32 v8, v3, 10, v2
    s_and_b32 s77, s29, 7
    s_lshr_b32 s62, s29, 3
    s_add_u32 s62, s62, s57
    s_lshl_b32 s62, s62, 13
    s_lshl_b32 s75, s77, 7
    s_add_u32 s62, s62, s75
    s_lshl_b32 s75, s30, 11
    s_add_u32 s62, s62, s75
    s_add_u32 s62, s62, 0xa0000
    s_lshl_b32 s75, s28, 11
    s_lshl_b32 s76, s29, 4
    s_add_u32 s75, s75, s76
    s_add_u32 s63, s75, 0x40000
    v_lshlrev_b32 v9, 9, v1
    v_lshrrev_b32 v2, 2, v1
    v_and_b32 v2, 15, v2
    v_lshrrev_b32 v3, 1, v2
    v_and_b32 v3, 3, v3
    v_xor_b32 v3, s30, v3
    v_lshlrev_b32 v3, 5, v3
    v_lshl_add_u32 v3, v2, 7, v3
    v_and_b32 v2, 3, v1
    v_lshl_add_u32 v3, v2, 3, v3
    v_add_u32 v10, 114688, v3
    v_and_b32 v2, 1, v1
    v_lshlrev_b32 v2, 10, v2
    v_lshrrev_b32 v3, 4, v1
    v_lshl_add_u32 v2, v3, 3, v2
    s_lshl_b32 s75, s77, 7
    s_add_u32 s75, s75, 131072
    v_add_u32 v11, s75, v2
    v_lshrrev_b32 v40, 2, v1
    v_and_b32 v40, 15, v40
    v_and_b32 v41, 7, v40
    v_lshlrev_b32 v40, 8, v40
    s_lshl_b32 s75, s30, 1
    v_xor_b32 v41, s75, v41
    v_lshl_add_u32 v40, v41, 5, v40
    v_and_b32 v41, 3, v1
    v_lshl_add_u32 v12, v41, 3, v40
    v_add_u32 v12, 65536, v12
    v_xor_b32 v13, 32, v12
    v_lshlrev_b32 v14, 4, v1
    s_lshl_b32 s75, s30, 2
    s_add_u32 s75, s75, 136192
    v_add_u32 v14, s75, v14
    v_and_b32 v15, 3, v1
    v_lshlrev_b32 v15, 4, v15
    v_add_u32 v15, 136192, v15
    s_waitcnt lgkmcnt(0)
    s_add_u32 s31, s31, 1
    s_and_b32 s72, s31, 0x3ff
    v_mov_b32 v20, s72
    s_cmp_ge_u32 s29, s59
    s_cbranch_scc1 Lguskip_1
    s_mov_b32 s74, 1048576
Lw_2:
    ds_read_b32 v24, v18 offset:0
    s_waitcnt lgkmcnt(0)
    v_readfirstlane_b32 s75, v24
    s_nop 0
    s_cmp_ge_u32 s75, 1
    s_cbranch_scc1 Lwd_3
    s_sleep 1
    s_sub_u32 s74, s74, 1
    s_cbranch_scc0 Lw_2
    s_branch L_end
Lwd_3:
    ds_read2_b64 v[64:67], v11 offset0:0 offset1:4
    ds_read2_b64 v[68:71], v11 offset0:8 offset1:12
    s_mov_b32 s74, 1048576
Lw_4:
    ds_read_b32 v24, v18 offset:20
    s_waitcnt lgkmcnt(0)
    v_readfirstlane_b32 s75, v24
    s_nop 0
    s_cmp_ge_u32 s75, 16
    s_cbranch_scc1 Lwd_5
    s_sleep 1
    s_sub_u32 s74, s74, 1
    s_cbranch_scc0 Lw_4
    s_branch L_end
Lwd_5:
    ds_read_b64_tr_b16 v[80:81], v10 offset:0
    ds_read_b64_tr_b16 v[82:83], v10 offset:2048
    ds_read_b64_tr_b16 v[84:85], v10 offset:4096
    ds_read_b64_tr_b16 v[86:87], v10 offset:6144
    ds_read_b64_tr_b16 v[88:89], v10 offset:8192
    ds_read_b64_tr_b16 v[90:91], v10 offset:10240
    ds_read_b64_tr_b16 v[92:93], v10 offset:12288
    ds_read_b64_tr_b16 v[94:95], v10 offset:14336
    s_waitcnt lgkmcnt(0)
    s_mov_b64 exec, 1
    ds_add_u32 v18, v19 offset:32
    s_mov_b64 exec, -1
    v_mfma_f32_16x16x32_bf16 v[112:115], v[80:83], v[64:67], 0
    v_mfma_f32_16x16x32_bf16 v[116:119], v[88:91], v[64:67], 0
    v_mfma_f32_16x16x32_bf16 v[112:115], v[84:87], v[68:71], v[112:115]
    v_mfma_f32_16x16x32_bf16 v[116:119], v[92:95], v[68:71], v[116:119]
    s_nop 6
    v_and_or_b32 v112, v112, s73, v20
    v_and_or_b32 v113, v113, s73, v20
    v_and_or_b32 v114, v114, s73, v20
    v_and_or_b32 v115, v115, s73, v20
    v_and_or_b32 v116, v116, s73, v20
    v_and_or_b32 v117, v117, s73, v20
    v_and_or_b32 v118, v118, s73, v20
    v_and_or_b32 v119, v119, s73, v20
    s_mov_b32 s74, 1048576
Lw_6:
    ds_read_b32 v24, v18 offset:36
    s_waitcnt lgkmcnt(0)
    v_readfirstlane_b32 s75, v24
    s_nop 0
    s_cmp_ge_u32 s75, 1
    s_cbranch_scc1 Lwd_7
    s_sleep 1
    s_sub_u32 s74, s74, 1
    s_cbranch_scc0 Lw_6
    s_branch L_end
Lwd_7:
    s_mov_b32 s58, s75
    s_mov_b32 exec_lo, 0x00030003
    s_mov_b32 exec_hi, 0x00030003
    s_cmp_eq_u32 s58, 2
    s_cbranch_scc1 Lpl_8
    buffer_store_dwordx4 v[112:115], v8, s[68:71], s62 offen offset:0 sc1
    buffer_store_dwordx4 v[116:119], v8, s[68:71], s62 offen offset:64 sc1
    s_branch Lpe_9
Lpl_8:
    buffer_store_dwordx4 v[112:115], v8, s[68:71], s62 offen offset:0
    buffer_store_dwordx4 v[116:119], v8, s[68:71], s62 offen offset:64
Lpe_9:
    s_mov_b64 exec, -1
Lguskip_1:
    s_mov_b32 s74, 1048576
Lw_10:
    ds_read_b32 v24, v18 offset:36
    s_waitcnt lgkmcnt(0)
    v_readfirstlane_b32 s75, v24
    s_nop 0
    s_cmp_ge_u32 s75, 1
    s_cbranch_scc1 Lwd_11
    s_sleep 1
    s_sub_u32 s74, s74, 1
    s_cbranch_scc0 Lw_10
    s_branch L_end
Lwd_11:
    s_mov_b32 s58, s75
    s_lshl_b32 s76, s30, 4
    s_add_u32 s76, s76, 32
    s_mov_b32 s74, 1048576
Lw_12:
    ds_read_b32 v24, v18 offset:20
    s_waitcnt lgkmcnt(0)
    v_readfirstlane_b32 s75, v24
    s_nop 0
    s_cmp_ge_u32 s75, s76
    s_cbranch_scc1 Lwd_13
    s_sleep 1
    s_sub_u32 s74, s74, 1
    s_cbranch_scc0 Lw_12
    s_branch L_end
Lwd_13:
    ds_read_b128 v[64:67], v244 offset:0
    ds_read_b128 v[68:71], v245 offset:0
    ds_read_b128 v[72:75], v246 offset:0
    ds_read_b128 v[76:79], v247 offset:0
    ds_read_b128 v[80:83], v244 offset:4096
    ds_read_b128 v[84:87], v245 offset:4096
    ds_read_b128 v[88:91], v246 offset:4096
    ds_read_b128 v[92:95], v247 offset:4096
    ds_read_b128 v[96:99], v244 offset:8192
    ds_read_b128 v[100:103], v245 offset:8192
    ds_read_b128 v[104:107], v246 offset:8192
    ds_read_b128 v[108:111], v247 offset:8192
    ds_read_b128 v[112:115], v244 offset:12288
    ds_read_b128 v[116:119], v245 offset:12288
    ds_read_b128 v[120:123], v246 offset:12288
    ds_read_b128 v[124:127], v247 offset:12288
    s_waitcnt lgkmcnt(0)
    s_mov_b64 exec, 1
    ds_add_u32 v18, v19 offset:44
    s_mov_b64 exec, -1
    s_mov_b32 s74, 1048576
Lw_14:
    ds_read_b32 v24, v18 offset:8
    s_waitcnt lgkmcnt(0)
    v_readfirstlane_b32 s75, v24
    s_nop 0
    s_cmp_ge_u32 s75, 1
    s_cbranch_scc1 Lwd_15
    s_sub_u32 s74, s74, 1
    s_cbranch_scc0 Lw_14
    s_branch L_end
Lwd_15:
    ds_read_b128 v[128:131], v21 offset:0
    ds_read_b128 v[132:135], v21 offset:64
    ds_read_b128 v[136:139], v21 offset:128
    ds_read_b128 v[140:143], v21 offset:192
    s_waitcnt lgkmcnt(0)
    v_mfma_f32_16x16x32_bf16 v[160:163], v[64:67], v[128:131], 0
    v_mfma_f32_16x16x32_bf16 v[164:167], v[80:83], v[128:131], 0
    v_mfma_f32_16x16x32_bf16 v[168:171], v[96:99], v[128:131], 0
    v_mfma_f32_16x16x32_bf16 v[172:175], v[112:115], v[128:131], 0
    v_mfma_f32_16x16x32_bf16 v[160:163], v[68:71], v[132:135], v[160:163]
    v_mfma_f32_16x16x32_bf16 v[164:167], v[84:87], v[132:135], v[164:167]
    v_mfma_f32_16x16x32_bf16 v[168:171], v[100:103], v[132:135], v[168:171]
    v_mfma_f32_16x16x32_bf16 v[172:175], v[116:119], v[132:135], v[172:175]
    v_mfma_f32_16x16x32_bf16 v[160:163], v[72:75], v[136:139], v[160:163]
    v_mfma_f32_16x16x32_bf16 v[164:167], v[88:91], v[136:139], v[164:167]
    v_mfma_f32_16x16x32_bf16 v[168:171], v[104:107], v[136:139], v[168:171]
    v_mfma_f32_16x16x32_bf16 v[172:175], v[120:123], v[136:139], v[172:175]
    v_mfma_f32_16x16x32_bf16 v[160:163], v[76:79], v[140:143], v[160:163]
    v_mfma_f32_16x16x32_bf16 v[164:167], v[92:95], v[140:143], v[164:167]
    v_mfma_f32_16x16x32_bf16 v[168:171], v[108:111], v[140:143], v[168:171]
    v_mfma_f32_16x16x32_bf16 v[172:175], v[124:127], v[140:143], v[172:175]
    s_nop 4
    v_mov_b32_dpp v24, v160 quad_perm:[0,1,2,3] row_mask:0xf bank_mask:0x1
    v_mov_b32_dpp v24, v164 quad_perm:[0,1,2,3] row_mask:0xf bank_mask:0x2
    v_mov_b32_dpp v24, v168 quad_perm:[0,1,2,3] row_mask:0xf bank_mask:0x4
    v_mov_b32_dpp v24, v172 quad_perm:[0,1,2,3] row_mask:0xf bank_mask:0x8
    v_mov_b32_dpp v25, v161 quad_perm:[0,1,2,3] row_mask:0xf bank_mask:0x1
    v_mov_b32_dpp v25, v165 quad_perm:[0,1,2,3] row_mask:0xf bank_mask:0x2
    v_mov_b32_dpp v25, v169 quad_perm:[0,1,2,3] row_mask:0xf bank_mask:0x4
    v_mov_b32_dpp v25, v173 quad_perm:[0,1,2,3] row_mask:0xf bank_mask:0x8
    v_mov_b32_dpp v26, v162 quad_perm:[0,1,2,3] row_mask:0xf bank_mask:0x1
    v_mov_b32_dpp v26, v166 quad_perm:[0,1,2,3] row_mask:0xf bank_mask:0x2
    v_mov_b32_dpp v26, v170 quad_perm:[0,1,2,3] row_mask:0xf bank_mask:0x4
    v_mov_b32_dpp v26, v174 quad_perm:[0,1,2,3] row_mask:0xf bank_mask:0x8
    v_mov_b32_dpp v27, v163 quad_perm:[0,1,2,3] row_mask:0xf bank_mask:0x1
    v_mov_b32_dpp v27, v167 quad_perm:[0,1,2,3] row_mask:0xf bank_mask:0x2
    v_mov_b32_dpp v27, v171 quad_perm:[0,1,2,3] row_mask:0xf bank_mask:0x4
    v_mov_b32_dpp v27, v175 quad_perm:[0,1,2,3] row_mask:0xf bank_mask:0x8
    s_mov_b32 s76, 0x3db504f3
    v_cvt_pk_bf16_f32 v40, v24, v25
    v_cvt_pk_bf16_f32 v41, v26, v27
    v_lshlrev_b32 v24, 16, v40
    v_and_b32 v25, 0xffff0000, v40
    v_lshlrev_b32 v26, 16, v41
    v_and_b32 v27, 0xffff0000, v41
    v_mul_f32 v24, s76, v24
    v_mul_f32 v25, s76, v25
    v_mul_f32 v26, s76, v26
    v_mul_f32 v27, s76, v27
    v_cvt_pk_bf16_f32 v40, v24, v25
    v_cvt_pk_bf16_f32 v41, v26, v27
    v_lshlrev_b32 v24, 16, v40
    v_and_b32 v25, 0xffff0000, v40
    v_lshlrev_b32 v26, 16, v41
    v_and_b32 v27, 0xffff0000, v41
    v_max3_f32 v40, v24, v25, v26
    v_max_f32 v40, v40, v27
    s_nop 1
    v_max_f32_dpp v40, v40, v40 row_ror:4 row_mask:0xf bank_mask:0xf
    s_nop 1
    v_max_f32_dpp v40, v40, v40 row_ror:8 row_mask:0xf bank_mask:0xf
    v_mov_b32 v41, v40
    s_nop 1
    v_permlane16_swap_b32 v40, v41
    v_max_f32 v40, v40, v41
    v_mov_b32 v41, v40
    s_nop 1
    v_permlane32_swap_b32 v40, v41
    v_max_f32 v40, v40, v41
    s_mov_b64 exec, 15
    ds_write_b32 v14, v40
    s_mov_b64 exec, 1
    ds_add_u32 v18, v19 offset:12
    s_mov_b64 exec, -1
    s_mov_b32 s74, 1048576
Lw_16:
    ds_read_b32 v44, v18 offset:12
    s_waitcnt lgkmcnt(0)
    v_readfirstlane_b32 s75, v44
    s_nop 0
    s_cmp_ge_u32 s75, 4
    s_cbranch_scc1 Lwd_17
    s_sub_u32 s74, s74, 1
    s_cbranch_scc0 Lw_16
    s_branch L_end
Lwd_17:
    ds_read_b128 v[44:47], v15
    s_waitcnt lgkmcnt(0)
    v_max3_f32 v48, v44, v45, v46
    v_max_f32 v48, v48, v47
    s_mov_b32 s76, 0x3fb8aa3b
    v_mul_f32 v49, s76, v48
    v_sub_f32 v49, 0, v49
    v_fma_f32 v24, v24, s76, v49
    v_fma_f32 v25, v25, s76, v49
    v_fma_f32 v26, v26, s76, v49
    v_fma_f32 v27, v27, s76, v49
    v_exp_f32 v24, v24
    v_exp_f32 v25, v25
    v_exp_f32 v26, v26
    v_exp_f32 v27, v27
    v_cvt_pk_bf16_f32 v42, v24, v25
    v_cvt_pk_bf16_f32 v43, v26, v27
    ds_write_b64 v22, v[42:43]
    v_add_f32 v50, v24, v25
    v_add_f32 v51, v26, v27
    v_add_f32 v50, v50, v51
    s_nop 1
    v_add_f32_dpp v50, v50, v50 row_ror:4 row_mask:0xf bank_mask:0xf
    s_nop 1
    v_add_f32_dpp v50, v50, v50 row_ror:8 row_mask:0xf bank_mask:0xf
    v_mov_b32 v51, v50
    s_nop 1
    v_permlane16_swap_b32 v50, v51
    v_add_f32 v50, v50, v51
    v_mov_b32 v51, v50
    s_nop 1
    v_permlane32_swap_b32 v50, v51
    v_add_f32 v50, v50, v51
    s_mov_b64 exec, 15
    ds_write_b32 v14, v50 offset:64
    s_mov_b64 exec, 1
    ds_add_u32 v18, v19 offset:16
    s_mov_b64 exec, -1
    s_mov_b32 s74, 1048576
Lw_18:
    ds_read_b32 v44, v18 offset:16
    s_waitcnt lgkmcnt(0)
    v_readfirstlane_b32 s75, v44
    s_nop 0
    s_cmp_ge_u32 s75, 4
    s_cbranch_scc1 Lwd_19
    s_sub_u32 s74, s74, 1
    s_cbranch_scc0 Lw_18
    s_branch L_end
Lwd_19:
    ds_read_b128 v[176:179], v23 offset:0
    ds_read_b128 v[180:183], v23 offset:256
    ds_read_b128 v[184:187], v23 offset:512
    ds_read_b128 v[188:191], v23 offset:768
    ds_read_b128 v[192:195], v23 offset:1024
    ds_read_b128 v[196:199], v23 offset:1280
    ds_read_b128 v[200:203], v23 offset:1536
    ds_read_b128 v[204:207], v23 offset:1792
    s_cmp_lg_u32 s30, 0
    s_cbranch_scc1 Lns_20
    ds_read_b128 v[44:47], v15 offset:64
    s_waitcnt lgkmcnt(0)
    v_add_f32 v44, v44, v45
    v_add_f32 v46, v46, v47
    v_add_f32 v45, v44, v46
    v_and_or_b32 v44, v48, s73, v20
    v_and_or_b32 v45, v45, s73, v20
    v_mov_b32 v46, v20
    v_mov_b32 v47, v20
    s_mov_b64 exec, 15
    s_cmp_eq_u32 s58, 2
    s_cbranch_scc1 Lpl_21
    buffer_store_dwordx4 v[44:47], v9, s[68:71], s63 offen sc1
    s_branch Lpe_22
Lpl_21:
    buffer_store_dwordx4 v[44:47], v9, s[68:71], s63 offen
Lpe_22:
    s_mov_b64 exec, -1
    s_mov_b64 exec, 1
    ds_add_u32 v18, v19 offset:16
    s_mov_b64 exec, -1
Lns_20:
    s_mov_b32 s77, 0
    s_cmp_ge_u32 s77, 88
    s_cbranch_scc1 Lvok_23
    s_mov_b32 s74, 1048576
Lw_24:
    ds_read_b32 v40, v18 offset:20
    s_waitcnt lgkmcnt(0)
    v_readfirstlane_b32 s75, v40
    s_nop 0
    s_cmp_ge_u32 s75, 88
    s_cbranch_scc1 Lwd_25
    s_sub_u32 s74, s74, 1
    s_cbranch_scc0 Lw_24
    s_branch L_end
Lwd_25:
    s_mov_b32 s77, s75
Lvok_23:
    ds_read_b64_tr_b16 v[208:209], v12 offset:0
    ds_read_b64_tr_b16 v[210:211], v12 offset:4096
    ds_read_b64_tr_b16 v[212:213], v13 offset:0
    ds_read_b64_tr_b16 v[214:215], v13 offset:4096
    s_cmp_ge_u32 s77, 96
    s_cbranch_scc1 Lvok_26
    s_mov_b32 s74, 1048576
Lw_27:
    ds_read_b32 v40, v18 offset:20
    s_waitcnt lgkmcnt(0)
    v_readfirstlane_b32 s75, v40
    s_nop 0
    s_cmp_ge_u32 s75, 96
    s_cbranch_scc1 Lwd_28
    s_sub_u32 s74, s74, 1
    s_cbranch_scc0 Lw_27
    s_branch L_end
Lwd_28:
    s_mov_b32 s77, s75
Lvok_26:
    ds_read_b64_tr_b16 v[216:217], v12 offset:8192
    ds_read_b64_tr_b16 v[218:219], v12 offset:12288
    ds_read_b64_tr_b16 v[220:221], v13 offset:8192
    ds_read_b64_tr_b16 v[222:223], v13 offset:12288
    s_waitcnt lgkmcnt(4)
    v_mfma_f32_16x16x32_bf16 v[160:163], v[208:211], v[176:179], 0
    v_mfma_f32_16x16x32_bf16 v[164:167], v[212:215], v[176:179], 0
    s_cmp_ge_u32 s77, 104
    s_cbranch_scc1 Lvok_29
    s_mov_b32 s74, 1048576
Lw_30:
    ds_read_b32 v40, v18 offset:20
    s_waitcnt lgkmcnt(0)
    v_readfirstlane_b32 s75, v40
    s_nop 0
    s_cmp_ge_u32 s75, 104
    s_cbranch_scc1 Lwd_31
    s_sub_u32 s74, s74, 1
    s_cbranch_scc0 Lw_30
    s_branch L_end
Lwd_31:
    s_mov_b32 s77, s75
Lvok_29:
    ds_read_b64_tr_b16 v[208:209], v12 offset:16384
    ds_read_b64_tr_b16 v[210:211], v12 offset:20480
    ds_read_b64_tr_b16 v[212:213], v13 offset:16384
    ds_read_b64_tr_b16 v[214:215], v13 offset:20480
    s_waitcnt lgkmcnt(4)
    v_mfma_f32_16x16x32_bf16 v[160:163], v[216:219], v[180:183], v[160:163]
    v_mfma_f32_16x16x32_bf16 v[164:167], v[220:223], v[180:183], v[164:167]
    s_cmp_ge_u32 s77, 112
    s_cbranch_scc1 Lvok_32
    s_mov_b32 s74, 1048576
Lw_33:
    ds_read_b32 v40, v18 offset:20
    s_waitcnt lgkmcnt(0)
    v_readfirstlane_b32 s75, v40
    s_nop 0
    s_cmp_ge_u32 s75, 112
    s_cbranch_scc1 Lwd_34
    s_sub_u32 s74, s74, 1
    s_cbranch_scc0 Lw_33
    s_branch L_end
Lwd_34:
    s_mov_b32 s77, s75
Lvok_32:
    ds_read_b64_tr_b16 v[216:217], v12 offset:24576
    ds_read_b64_tr_b16 v[218:219], v12 offset:28672
    ds_read_b64_tr_b16 v[220:221], v13 offset:24576
    ds_read_b64_tr_b16 v[222:223], v13 offset:28672
    s_waitcnt lgkmcnt(4)
    v_mfma_f32_16x16x32_bf16 v[160:163], v[208:211], v[184:187], v[160:163]
    v_mfma_f32_16x16x32_bf16 v[164:167], v[212:215], v[184:187], v[164:167]
    s_cmp_ge_u32 s77, 120
    s_cbranch_scc1 Lvok_35
    s_mov_b32 s74, 1048576
Lw_36:
    ds_read_b32 v40, v18 offset:20
    s_waitcnt lgkmcnt(0)
    v_readfirstlane_b32 s75, v40
    s_nop 0
    s_cmp_ge_u32 s75, 120
    s_cbranch_scc1 Lwd_37
    s_sub_u32 s74, s74, 1
    s_cbranch_scc0 Lw_36
    s_branch L_end
Lwd_37:
    s_mov_b32 s77, s75
Lvok_35:
    ds_read_b64_tr_b16 v[208:209], v12 offset:32768
    ds_read_b64_tr_b16 v[210:211], v12 offset:36864
    ds_read_b64_tr_b16 v[212:213], v13 offset:32768
    ds_read_b64_tr_b16 v[214:215], v13 offset:36864
    s_waitcnt lgkmcnt(4)
    v_mfma_f32_16x16x32_bf16 v[160:163], v[216:219], v[188:191], v[160:163]
    v_mfma_f32_16x16x32_bf16 v[164:167], v[220:223], v[188:191], v[164:167]
    s_cmp_ge_u32 s77, 128
    s_cbranch_scc1 Lvok_38
    s_mov_b32 s74, 1048576
Lw_39:
    ds_read_b32 v40, v18 offset:20
    s_waitcnt lgkmcnt(0)
    v_readfirstlane_b32 s75, v40
    s_nop 0
    s_cmp_ge_u32 s75, 128
    s_cbranch_scc1 Lwd_40
    s_sub_u32 s74, s74, 1
    s_cbranch_scc0 Lw_39
    s_branch L_end
Lwd_40:
    s_mov_b32 s77, s75
Lvok_38:
    ds_read_b64_tr_b16 v[216:217], v12 offset:40960
    ds_read_b64_tr_b16 v[218:219], v12 offset:45056
    ds_read_b64_tr_b16 v[220:221], v13 offset:40960
    ds_read_b64_tr_b16 v[222:223], v13 offset:45056
    s_waitcnt lgkmcnt(4)
    v_mfma_f32_16x16x32_bf16 v[160:163], v[208:211], v[192:195], v[160:163]
    v_mfma_f32_16x16x32_bf16 v[164:167], v[212:215], v[192:195], v[164:167]
    s_cmp_ge_u32 s77, 136
    s_cbranch_scc1 Lvok_41
    s_mov_b32 s74, 1048576
Lw_42:
    ds_read_b32 v40, v18 offset:20
    s_waitcnt lgkmcnt(0)
    v_readfirstlane_b32 s75, v40
    s_nop 0
    s_cmp_ge_u32 s75, 136
    s_cbranch_scc1 Lwd_43
    s_sub_u32 s74, s74, 1
    s_cbranch_scc0 Lw_42
    s_branch L_end
Lwd_43:
    s_mov_b32 s77, s75
Lvok_41:
    ds_read_b64_tr_b16 v[208:209], v12 offset:49152
    ds_read_b64_tr_b16 v[210:211], v12 offset:53248
    ds_read_b64_tr_b16 v[212:213], v13 offset:49152
    ds_read_b64_tr_b16 v[214:215], v13 offset:53248
    s_waitcnt lgkmcnt(4)
    v_mfma_f32_16x16x32_bf16 v[160:163], v[216:219], v[196:199], v[160:163]
    v_mfma_f32_16x16x32_bf16 v[164:167], v[220:223], v[196:199], v[164:167]
    s_cmp_ge_u32 s77, 144
    s_cbranch_scc1 Lvok_44
    s_mov_b32 s74, 1048576
Lw_45:
    ds_read_b32 v40, v18 offset:20
    s_waitcnt lgkmcnt(0)
    v_readfirstlane_b32 s75, v40
    s_nop 0
    s_cmp_ge_u32 s75, 144
    s_cbranch_scc1 Lwd_46
    s_sub_u32 s74, s74, 1
    s_cbranch_scc0 Lw_45
    s_branch L_end
Lwd_46:
    s_mov_b32 s77, s75
Lvok_44:
    ds_read_b64_tr_b16 v[216:217], v12 offset:57344
    ds_read_b64_tr_b16 v[218:219], v12 offset:61440
    ds_read_b64_tr_b16 v[220:221], v13 offset:57344
    ds_read_b64_tr_b16 v[222:223], v13 offset:61440
    s_waitcnt lgkmcnt(4)
    v_mfma_f32_16x16x32_bf16 v[160:163], v[208:211], v[200:203], v[160:163]
    v_mfma_f32_16x16x32_bf16 v[164:167], v[212:215], v[200:203], v[164:167]
    s_waitcnt lgkmcnt(0)
    v_mfma_f32_16x16x32_bf16 v[160:163], v[216:219], v[204:207], v[160:163]
    v_mfma_f32_16x16x32_bf16 v[164:167], v[220:223], v[204:207], v[164:167]
    s_nop 6
    v_and_or_b32 v160, v160, s73, v20
    v_and_or_b32 v161, v161, s73, v20
    v_and_or_b32 v162, v162, s73, v20
    v_and_or_b32 v163, v163, s73, v20
    v_and_or_b32 v164, v164, s73, v20
    v_and_or_b32 v165, v165, s73, v20
    v_and_or_b32 v166, v166, s73, v20
    v_and_or_b32 v167, v167, s73, v20
    s_mov_b32 exec_lo, 0x000f000f
    s_mov_b32 exec_hi, 0x000f000f
    s_cmp_eq_u32 s58, 2
    s_cbranch_scc1 Lpl_47
    buffer_store_dwordx4 v[160:163], v4, s[68:71], s60 offen sc1
    buffer_store_dwordx4 v[164:167], v4, s[68:71], s60 offen offset:2048 sc1
    s_branch Lpe_48
Lpl_47:
    buffer_store_dwordx4 v[160:163], v4, s[68:71], s60 offen
    buffer_store_dwordx4 v[164:167], v4, s[68:71], s60 offen offset:2048
Lpe_48:
    s_mov_b64 exec, 1
    ds_add_u32 v18, v19 offset:40
    s_mov_b64 exec, -1
    s_cmp_lt_u32 s29, s56
    s_cbranch_scc1 Lnoffn_49
    s_mov_b32 s74, 1048576
Lw_51:
    ds_read_b32 v40, v18 offset:20
    s_waitcnt lgkmcnt(0)
    v_readfirstlane_b32 s75, v40
    s_nop 0
    s_cmp_ge_u32 s75, 168
    s_cbranch_scc1 Lwd_52
    s_sub_u32 s74, s74, 1
    s_cbranch_scc0 Lw_51
    s_branch L_end
Lwd_52:
    v_add_u32 v42, 16384, v5
    ds_read_b128 v[228:231], v42 offset:0
    ds_read_b128 v[232:235], v42 offset:4096
    s_mov_b32 s74, 1048576
Lw_53:
    ds_read_b32 v40, v18 offset:24
    ds_read_b128 v[44:47], v6 offset:128
    s_waitcnt lgkmcnt(0)
    v_readfirstlane_b32 s75, v40
    s_nop 0
    s_cmp_ge_u32 s75, 1
    s_cbranch_scc1 Lwd_54
    s_sub_u32 s74, s74, 1
    s_cbranch_scc0 Lw_53
    s_branch L_end
Lwd_54:
    v_and_b32 v144, v44, v224
    v_and_b32 v145, v44, v225
    v_and_b32 v146, v44, v226
    v_and_b32 v147, v44, v227
    v_and_b32 v148, v45, v224
    v_and_b32 v149, v45, v225
    v_and_b32 v150, v45, v226
    v_and_b32 v151, v45, v227
    v_mfma_f32_16x16x32_bf16 v[168:171], v[144:147], v[228:231], 0
    s_nop 0
    v_mfma_f32_16x16x32_bf16 v[168:171], v[148:151], v[232:235], v[168:171]
    v_add_u32 v42, 0, v5
    ds_read_b128 v[228:231], v42 offset:0
    ds_read_b128 v[232:235], v42 offset:4096
    ds_read_b128 v[236:239], v42 offset:8192
    ds_read_b128 v[240:243], v42 offset:12288
    s_mov_b32 s74, 1048576
Lw_55:
    ds_read_b32 v40, v18 offset:28
    ds_read_b128 v[44:47], v6 offset:0
    s_waitcnt lgkmcnt(0)
    v_readfirstlane_b32 s75, v40
    s_nop 0
    s_cmp_ge_u32 s75, 1
    s_cbranch_scc1 Lwd_56
    s_sub_u32 s74, s74, 1
    s_cbranch_scc0 Lw_55
    s_branch L_end
Lwd_56:
    v_and_b32 v144, v44, v224
    v_and_b32 v145, v44, v225
    v_and_b32 v146, v44, v226
    v_and_b32 v147, v44, v227
    v_and_b32 v148, v45, v224
    v_and_b32 v149, v45, v225
    v_and_b32 v150, v45, v226
    v_and_b32 v151, v45, v227
    v_and_b32 v152, v46, v224
    v_and_b32 v153, v46, v225
    v_and_b32 v154, v46, v226
    v_and_b32 v155, v46, v227
    v_and_b32 v156, v47, v224
    v_and_b32 v157, v47, v225
    v_and_b32 v158, v47, v226
    v_and_b32 v159, v47, v227
    v_mfma_f32_16x16x32_bf16 v[168:171], v[144:147], v[228:231], v[168:171]
    v_mfma_f32_16x16x32_bf16 v[168:171], v[148:151], v[232:235], v[168:171]
    v_mfma_f32_16x16x32_bf16 v[168:171], v[152:155], v[236:239], v[168:171]
    v_mfma_f32_16x16x32_bf16 v[168:171], v[156:159], v[240:243], v[168:171]
    s_branch Ljoin_50
Lnoffn_49:
    s_mov_b32 s74, 1048576
Lw_57:
    ds_read_b32 v40, v18 offset:20
    s_waitcnt lgkmcnt(0)
    v_readfirstlane_b32 s75, v40
    s_nop 0
    s_cmp_ge_u32 s75, 160
    s_cbranch_scc1 Lwd_58
    s_sub_u32 s74, s74, 1
    s_cbranch_scc0 Lw_57
    s_branch L_end
Lwd_58:
    v_add_u32 v42, 0, v5
    ds_read_b128 v[228:231], v42 offset:0
    ds_read_b128 v[232:235], v42 offset:4096
    ds_read_b128 v[236:239], v42 offset:8192
    ds_read_b128 v[240:243], v42 offset:12288
    s_mov_b32 s74, 1048576
Lw_59:
    ds_read_b32 v40, v18 offset:28
    ds_read_b128 v[44:47], v6 offset:0
    s_waitcnt lgkmcnt(0)
    v_readfirstlane_b32 s75, v40
    s_nop 0
    s_cmp_ge_u32 s75, 1
    s_cbranch_scc1 Lwd_60
    s_sub_u32 s74, s74, 1
    s_cbranch_scc0 Lw_59
    s_branch L_end
Lwd_60:
    v_and_b32 v144, v44, v224
    v_and_b32 v145, v44, v225
    v_and_b32 v146, v44, v226
    v_and_b32 v147, v44, v227
    v_and_b32 v148, v45, v224
    v_and_b32 v149, v45, v225
    v_and_b32 v150, v45, v226
    v_and_b32 v151, v45, v227
    v_and_b32 v152, v46, v224
    v_and_b32 v153, v46, v225
    v_and_b32 v154, v46, v226
    v_and_b32 v155, v46, v227
    v_and_b32 v156, v47, v224
    v_and_b32 v157, v47, v225
    v_and_b32 v158, v47, v226
    v_and_b32 v159, v47, v227
    v_mfma_f32_16x16x32_bf16 v[168:171], v[144:147], v[228:231], 0
    v_mfma_f32_16x16x32_bf16 v[168:171], v[148:151], v[232:235], v[168:171]
    v_mfma_f32_16x16x32_bf16 v[168:171], v[152:155], v[236:239], v[168:171]
    v_mfma_f32_16x16x32_bf16 v[168:171], v[156:159], v[240:243], v[168:171]
Ljoin_50:
    s_nop 7
    v_and_or_b32 v168, v168, s73, v20
    v_and_or_b32 v169, v169, s73, v20
    v_and_or_b32 v170, v170, s73, v20
    v_and_or_b32 v171, v171, s73, v20
    s_cmp_eq_u32 s58, 2
    s_cbranch_scc1 Lpl_61
    buffer_store_dwordx4 v[168:171], v7, s[68:71], s61 offen sc1
    s_branch Lpe_62
Lpl_61:
    buffer_store_dwordx4 v[168:171], v7, s[68:71], s61 offen
Lpe_62:
    s_endpgm
L_end:
    s_endpgm
.section .rodata,"a"
.p2align 6
.amdhsa_kernel parallel_sum__sliding_block_cached__glu_gated_glu__decode_kernel
  .amdhsa_next_free_vgpr 256
  .amdhsa_next_free_sgpr 102
  .amdhsa_accum_offset 256
  .amdhsa_group_segment_fixed_size 0
  .amdhsa_kernarg_size 96
  .amdhsa_user_sgpr_count 2
  .amdhsa_user_sgpr_kernarg_segment_ptr 1
  .amdhsa_system_sgpr_workgroup_id_x 1
.end_amdhsa_kernel
```
